```python
import torch

def _softmax(x, axis=-1):
    return torch.softmax(x, dim=axis)
def _gelu(x):
    return torch.nn.functional.gelu(x, approximate="tanh")
def _silu(x):
    return torch.nn.functional.silu(x)
def _sigmoid(x):
    return torch.sigmoid(x)
def _layernorm(x, axis=-1, eps=1e-5):
    m = x.mean(dim=axis, keepdim=True)
    v = x.var(dim=axis, keepdim=True, unbiased=False)
    return (x - m) / torch.sqrt(v + eps)
def _scatter_add(tgt, idx, src, axis=0):
    return tgt.clone().index_add_(axis, idx, src)
def _segment_sum(src, seg, n):
    out = torch.zeros((n,) + src.shape[1:], dtype=src.dtype)
    return out.index_add_(0, seg, src)
def _pad(x, pw):
    flat = tuple(v for pair in reversed(pw) for v in pair)
    return torch.nn.functional.pad(x, flat)

kernel_name = 'sequential_preLN__sliding_block_cached__glu_gated_glu__decode'

def setup_inputs():

    _w = (lambda a: (lambda t: t.to(torch.bfloat16) if t.is_floating_point() else t)(torch.as_tensor(a)))
    def _A_setup():
        B, Sq, D = 8, 1, 512
        Hq, Hkv, Sk, Dh = 32, 8, 4096, 128
        assert Hq % Hkv == 0, (Hq, Hkv)
        return {
            "x": _w((lambda *s: torch.randn(*s, dtype=torch.bfloat16) * 0.05)(B, Sq, D)),
            "k_cache": _w((lambda *s: torch.randn(*s, dtype=torch.bfloat16) * 3.2)(B, Hkv, Sk, Dh)),
            "v_cache": _w((lambda *s: torch.randn(*s, dtype=torch.bfloat16) * 0.4)(B, Hkv, Sk, Dh)),
            "wq": _w((lambda *s: torch.randn(*s, dtype=torch.bfloat16) * 3.2)(D, Hq * Dh) * (D ** -0.5)),
            "wo": _w((lambda *s: torch.randn(*s, dtype=torch.bfloat16) * 0.4)(Hq * Dh, D) * ((Hq * Dh) ** -0.5)),
        }
    _A_in = _A_setup()

    def _B_setup():
        B, S, D, F = 8, 1, 512, 1792
        return {
            "x": _w((lambda *s: torch.randn(*s, dtype=torch.bfloat16) * 0.05)(B, S, D)),
            "w_gate": _w((lambda *s: torch.randn(*s, dtype=torch.bfloat16) * 0.1)(D, F)),
            "w_up": _w((lambda *s: torch.randn(*s, dtype=torch.bfloat16) * 0.05)(D, F)),
            "w_down": _w((lambda *s: torch.randn(*s, dtype=torch.bfloat16) * 0.05)(F, D)),
        }
    _B_in = _B_setup()

    return {
        "A_x": _A_in["x"],
        "A_k_cache": _A_in["k_cache"],
        "A_v_cache": _A_in["v_cache"],
        "A_wq": _A_in["wq"],
        "A_wo": _A_in["wo"],
        "B_x": _B_in["x"],
        "B_w_gate": _B_in["w_gate"],
        "B_w_up": _B_in["w_up"],
        "B_w_down": _B_in["w_down"],
    }

def reference(A_x, A_k_cache, A_v_cache, A_wq, A_wo, B_x, B_w_gate, B_w_up, B_w_down):
    def _A_ref(x, k_cache, v_cache, wq, wo):
        B, Sq, D = x.shape
        Hq, Dh = 32, 128
        Hkv, Sk = k_cache.shape[1], k_cache.shape[2]
        W = min(4096, max(256, Sk // 4))
        rep = Hq // Hkv
        q = (lambda x, *d: x.permute(*d))((x @ wq).reshape(B, Sq, Hq, Dh), 0, 2, 1, 3)
        k = (lambda x, n, axis: torch.repeat_interleave(x, n, dim=axis))(k_cache[:, :, Sk - W:, :], rep, axis=1)
        v = (lambda x, n, axis: torch.repeat_interleave(x, n, dim=axis))(v_cache[:, :, Sk - W:, :], rep, axis=1)
        scores = torch.einsum("bhqd,bhkd->bhqk", q, k) * (Dh ** -0.5)
        p = _softmax(scores, axis=-1)
        o = torch.einsum("bhqk,bhkd->bhqd", p, v)
        return (lambda x, *d: x.permute(*d))(o, 0, 2, 1, 3).reshape(B, Sq, Hq * Dh) @ wo

    def _B_ref(x, w_gate, w_up, w_down):
        g = torch.einsum("bsd,df->bsf", x, w_gate)
        u = torch.einsum("bsd,df->bsf", x, w_up)
        h = _sigmoid(g) * u
        return torch.einsum("bsf,fd->bsd", h, w_down)

    x = A_x
    h = x + _A_ref(_layernorm(x, axis=-1), A_k_cache, A_v_cache, A_wq, A_wo)
    h2 = h + _B_ref(_layernorm(h, axis=-1), B_w_gate, B_w_up, B_w_down)
    return h2
```

```asm
; @launch grid=(256,1,1) block=(640,1,1) lds=143808
.amdgcn_target "amdgcn-amd-amdhsa--gfx950"
.text
.globl sequential_preLN__sliding_block_cached__glu_gated_glu__decode_kernel
.p2align 8
.type sequential_preLN__sliding_block_cached__glu_gated_glu__decode_kernel,@function
sequential_preLN__sliding_block_cached__glu_gated_glu__decode_kernel:
L_top:
    s_load_dwordx8 s[68:75], s[0:1], 0
    s_load_dwordx16 s[76:91], s[0:1], 32
    s_getpc_b64 s[60:61]
L_pc:
    v_lshrrev_b32 v9, 6, v0
    s_lshr_b32 s5, s2, 3
    v_lshl_add_u32 v2, v9, 5, s5
    v_min_u32 v2, (L_end-L_pc)>>7, v2
    v_lshlrev_b32 v2, 7, v2
    global_load_dword v127, v2, s[60:61]
    s_cmp_ge_u32 s5, 32
    s_cbranch_scc1 L_end
    v_readfirstlane_b32 s3, v9
    v_and_b32 v1, 63, v0
    s_and_b32 s4, s2, 7
    v_lshlrev_b32 v7, 4, v1
    s_cmp_lt_u32 s3, 2
    s_cbranch_scc0 L_kv
    s_barrier
    s_branch L_aux
L_kv:
    s_sub_u32 s3, s3, 2
    v_lshrrev_b32 v4, 3, v1
    v_and_b32 v5, 7, v1
    v_and_b32 v6, 2, v4
    v_xor_b32 v5, v5, v6
    v_lshlrev_b32 v5, 4, v5
    v_lshl_add_u32 v4, v4, 13, v5
    v_xor_b32 v5, 64, v4
    s_mov_b32 s10, 0x2000
    s_mov_b32 s11, 0x20000
    s_mov_b32 s22, 0x400000
    s_mov_b32 s23, 0x20000
    s_lshr_b32 s7, s5, 3
    s_and_b32 s7, s7, 2
    s_bitcmp1_b32 s5, 0
    s_addc_u32 s7, s7, 0
    s_lshl_b32 s7, s7, 3
    s_add_u32 s7, s7, s3
    s_lshl_b32 s51, s7, 17
    s_lshl_b32 s7, s4, 10
    s_add_u32 s51, s51, s7
    s_bfe_u32 s7, s5, 0x30001
    s_xor_b32 s7, s7, 4
    s_lshl_b32 s7, s7, 7
    s_add_u32 s51, s51, s7
    s_add_u32 s52, s51, 65536
    s_lshl_b32 s54, s3, 11
    s_lshl_b32 s55, s3, 10
    s_mov_b32 m0, s54
    s_waitcnt lgkmcnt(0)
    s_mov_b64 s[8:9], s[68:69]
    s_mov_b64 s[20:21], s[74:75]
    buffer_load_dwordx4 v[96:99], v7, s[8:11], s55 offen
    buffer_load_dwordx4 v4, s[20:23], s51 offen nt lds
    s_add_u32 m0, s54, 1024
    s_nop 0
    buffer_load_dwordx4 v5, s[20:23], s52 offen nt lds
L_q_late:
    s_mov_b32 s14, 0x4000000
    s_mov_b32 s15, 0x20000
    v_lshrrev_b32 v11, 4, v1
    v_and_b32 v12, 3, v1
    v_bfe_u32 v9, v1, 2, 2
    v_lshlrev_b32 v2, 4, v12
    v_lshl_add_u32 v2, v11, 6, v2
    v_lshl_add_u32 v2, v9, 10, v2
    s_lshr_b32 s7, s5, 2
    s_lshl_b32 s48, s7, 23
    s_lshl_b32 s7, s4, 20
    s_add_u32 s48, s48, s7
    s_and_b32 s7, s5, 3
    s_lshl_b32 s7, s7, 16
    s_add_u32 s48, s48, s7
    s_lshl_b32 s7, s3, 13
    s_add_u32 s48, s48, s7
    s_add_u32 s48, s48, 786432
    s_add_u32 s49, s48, 4096
    s_mov_b64 s[12:13], s[70:71]
    s_mov_b64 s[40:41], s[90:91]
    s_barrier
    buffer_load_dwordx4 v[16:19], v2, s[12:15], s48 offen offset:0 nt
    buffer_load_dwordx4 v[20:23], v2, s[12:15], s48 offen offset:512 nt
    buffer_load_dwordx4 v[24:27], v2, s[12:15], s49 offen offset:0 nt
    s_load_dword s100, s[40:41], 0
    s_mov_b64 s[16:17], s[72:73]
    s_mov_b64 s[24:25], s[76:77]
    s_mov_b64 s[28:29], s[80:81]
    s_mov_b64 s[32:33], s[82:83]
    s_mov_b64 s[44:45], s[84:85]
    s_mov_b64 s[36:37], s[86:87]
    s_mov_b32 s42, 0x10000000
    s_mov_b32 s43, 0x20000
    s_mov_b32 s18, 0x4000000
    s_mov_b32 s19, 0x20000
    s_mov_b32 s26, 0x400000
    s_mov_b32 s27, 0x20000
    s_mov_b32 s30, 0x1c0000
    s_mov_b32 s31, 0x20000
    s_mov_b32 s34, 0x1c0000
    s_mov_b32 s35, 0x20000
    s_mov_b32 s46, 0x1c0000
    s_mov_b32 s47, 0x20000
    s_lshl_b32 s6, s4, 17
    s_add_u32 s6, s6, 262144
    s_mov_b32 s56, 0xffff0000
    s_mov_b32 s96, 300000
    v_lshlrev_b32 v8, 3, v1
    v_and_b32 v10, 15, v1
    v_and_b32 v13, 1, v11
    v_lshrrev_b32 v14, 2, v1
    v_lshlrev_b32 v14, 6, v14
    v_lshl_add_u32 v14, v12, 3, v14
    v_lshl_add_u32 v14, v13, 5, v14
    v_lshl_add_u32 v9, v11, 3, v9
    v_lshlrev_b32 v13, 1, v13
    v_xor_b32 v12, v12, v13
    v_lshlrev_b32 v12, 4, v12
    v_lshl_add_u32 v5, v9, 10, v12
    v_mul_u32_u24 v6, 3584, v9
    v_add_u32 v6, v6, v12
    v_lshlrev_b32 v3, 4, v10
    v_lshl_add_u32 v3, v11, 10, v3
    s_and_b32 s50, s5, 1
    s_lshl_b32 s53, s3, 1
    s_add_u32 s53, s53, s50
    s_lshl_b32 s54, s53, 11
    s_xor_b32 s55, s54, 2048
    s_mul_i32 s7, s3, 1040
    s_add_u32 s7, s7, 115968
    v_add_u32 v13, s7, v7
    s_mov_b32 s57, 0x3f803f80
    v_mov_b32 v100, 0
    v_mov_b32 v101, 0
    v_mov_b32 v102, 0x3b000000
    s_waitcnt vmcnt(5)
    v_dot2c_f32_bf16 v100, s57, v96
    v_dot2c_f32_bf16 v101, v96, v96
    v_dot2c_f32_bf16 v100, s57, v97
    v_dot2c_f32_bf16 v101, v97, v97
    v_dot2c_f32_bf16 v100, s57, v98
    v_dot2c_f32_bf16 v101, v98, v98
    v_dot2c_f32_bf16 v100, s57, v99
    v_dot2c_f32_bf16 v101, v99, v99
    v_lshlrev_b32 v112, 16, v96
    v_and_b32 v113, s56, v96
    v_lshlrev_b32 v114, 16, v97
    v_and_b32 v115, s56, v97
    v_lshlrev_b32 v116, 16, v98
    v_and_b32 v117, s56, v98
    v_lshlrev_b32 v118, 16, v99
    v_and_b32 v119, s56, v99
    v_add_f32_dpp v100, v100, v100 quad_perm:[1,0,3,2] row_mask:0xf bank_mask:0xf
    v_add_f32_dpp v101, v101, v101 quad_perm:[1,0,3,2] row_mask:0xf bank_mask:0xf
    s_nop 0
    v_add_f32_dpp v100, v100, v100 quad_perm:[2,3,0,1] row_mask:0xf bank_mask:0xf
    v_add_f32_dpp v101, v101, v101 quad_perm:[2,3,0,1] row_mask:0xf bank_mask:0xf
    s_nop 0
    v_add_f32_dpp v100, v100, v100 row_half_mirror row_mask:0xf bank_mask:0xf
    v_add_f32_dpp v101, v101, v101 row_half_mirror row_mask:0xf bank_mask:0xf
    s_nop 0
    v_add_f32_dpp v100, v100, v100 row_mirror row_mask:0xf bank_mask:0xf
    v_add_f32_dpp v101, v101, v101 row_mirror row_mask:0xf bank_mask:0xf
    s_nop 0
    v_add_f32_dpp v100, v100, v100 row_bcast:15 row_mask:0xa bank_mask:0xf
    v_add_f32_dpp v101, v101, v101 row_bcast:15 row_mask:0xa bank_mask:0xf
    s_nop 0
    v_add_f32_dpp v100, v100, v100 row_bcast:31 row_mask:0xc bank_mask:0xf
    v_add_f32_dpp v101, v101, v101 row_bcast:31 row_mask:0xc bank_mask:0xf
    v_readlane_b32 s58, v100, 63
    v_readlane_b32 s59, v101, 63
    s_nop 0
    v_mul_f32 v110, s58, v102
    v_mul_f32 v111, s59, v102
    v_fma_f32 v111, -v110, v110, v111
    v_max_f32 v111, 0, v111
    v_cvt_pk_bf16_f32 v110, v110, v111
    v_and_b32 v111, s56, v110
    v_lshlrev_b32 v110, 16, v110
    v_add_f32 v111, 0x3727c5ac, v111
    v_cvt_pk_bf16_f32 v111, v111, v111
    v_and_b32 v111, s56, v111
    v_sqrt_f32 v111, v111
    s_nop 0
    v_pk_add_f32 v[112:113], v[112:113], v[110:111] op_sel_hi:[1,0] neg_lo:[0,1] neg_hi:[0,1]
    v_pk_add_f32 v[114:115], v[114:115], v[110:111] op_sel_hi:[1,0] neg_lo:[0,1] neg_hi:[0,1]
    v_pk_add_f32 v[116:117], v[116:117], v[110:111] op_sel_hi:[1,0] neg_lo:[0,1] neg_hi:[0,1]
    v_pk_add_f32 v[118:119], v[118:119], v[110:111] op_sel_hi:[1,0] neg_lo:[0,1] neg_hi:[0,1]
    v_cvt_pk_bf16_f32 v111, v111, v111
    v_and_b32 v111, s56, v111
    v_rcp_f32 v111, v111
    v_cvt_pk_bf16_f32 v96, v112, v113
    v_cvt_pk_bf16_f32 v97, v114, v115
    v_cvt_pk_bf16_f32 v98, v116, v117
    v_cvt_pk_bf16_f32 v99, v118, v119
    v_lshlrev_b32 v112, 16, v96
    v_and_b32 v113, s56, v96
    v_lshlrev_b32 v114, 16, v97
    v_and_b32 v115, s56, v97
    v_lshlrev_b32 v116, 16, v98
    v_and_b32 v117, s56, v98
    v_lshlrev_b32 v118, 16, v99
    v_and_b32 v119, s56, v99
    v_pk_mul_f32 v[112:113], v[112:113], v[110:111] op_sel:[0,1] op_sel_hi:[1,1]
    v_pk_mul_f32 v[114:115], v[114:115], v[110:111] op_sel:[0,1] op_sel_hi:[1,1]
    v_pk_mul_f32 v[116:117], v[116:117], v[110:111] op_sel:[0,1] op_sel_hi:[1,1]
    v_pk_mul_f32 v[118:119], v[118:119], v[110:111] op_sel:[0,1] op_sel_hi:[1,1]
    v_cvt_pk_bf16_f32 v96, v112, v113
    v_cvt_pk_bf16_f32 v97, v114, v115
    v_cvt_pk_bf16_f32 v98, v116, v117
    v_cvt_pk_bf16_f32 v99, v118, v119
    ds_write_b128 v13, v[96:99]
    buffer_load_dwordx4 v[28:31], v2, s[12:15], s49 offen offset:512 nt
    buffer_load_dwordx4 v[32:35], v2, s[12:15], s48 offen offset:256 nt
    v_mov_b32 v80, 0
    v_mov_b32 v81, 0
    v_mov_b32 v82, 0
    v_mov_b32 v83, 0
    v_mov_b32 v84, 0
    v_mov_b32 v85, 0
    v_mov_b32 v86, 0
    v_mov_b32 v87, 0
    v_mov_b32 v88, 0
    v_mov_b32 v89, 0
    v_mov_b32 v90, 0
    v_mov_b32 v91, 0
    v_mov_b32 v92, 0
    v_mov_b32 v93, 0
    v_mov_b32 v94, 0
    v_mov_b32 v95, 0
    v_add_u32 v13, 114688, v7
    v_and_b32 v12, 3, v10
    v_lshlrev_b32 v12, 5, v12
    v_add_u32 v12, 115712, v12
    s_lshl_b32 s7, s3, 2
    v_add_u32 v9, s7, v12
    s_mov_b32 s57, 0x3db504f3
    s_mov_b32 s58, 0x3fb8aa3b
    s_mov_b32 s59, 0x05040100
    s_mov_b32 s60, 0x07060302
    s_mul_i32 s7, s3, 1280
    s_add_u32 s7, s7, 132352
    v_mul_u32_u24 v15, 320, v11
    v_lshl_add_u32 v15, v10, 4, v15
    v_add_u32 v15, s7, v15
    s_lshr_b32 s7, s5, 2
    s_and_b32 s61, s5, 2
    s_lshl_b32 s61, s61, 2
    s_add_u32 s61, s61, s7
    s_lshl_b32 s98, s3, 13
    s_lshl_b32 s7, s50, 11
    s_add_u32 s98, s98, s7
    s_lshl_b32 s7, s61, 4
    s_add_u32 s98, s98, s7
    s_add_u32 s98, s98, s6
    s_lshl_b32 s99, s3, 4
    s_add_u32 s99, s99, s61
    s_lshl_b32 s99, s99, 1
    s_add_u32 s99, s99, s50
    s_lshl_b32 s99, s99, 2
    s_add_u32 s99, s99, s6
    s_add_u32 s99, s99, 41984
    s_waitcnt vmcnt(5) lgkmcnt(0)
    s_barrier
    s_barrier
    buffer_load_dwordx4 v[36:39], v2, s[12:15], s48 offen offset:768 nt
    buffer_load_dwordx4 v[40:43], v2, s[12:15], s49 offen offset:256 nt
    buffer_load_dwordx4 v[44:47], v2, s[12:15], s49 offen offset:768 nt
    s_barrier
    buffer_load_dwordx4 v[48:51], v3, s[16:19], s48 offen offset:0 nt
    buffer_load_dwordx4 v[52:55], v3, s[16:19], s48 offen offset:256 nt
    s_barrier
    s_barrier
    buffer_load_dwordx4 v[56:59], v3, s[16:19], s48 offen offset:512 nt
    buffer_load_dwordx4 v[60:63], v3, s[16:19], s48 offen offset:768 nt
    buffer_load_dwordx4 v[64:67], v3, s[16:19], s49 offen offset:0 nt
    buffer_load_dwordx4 v[68:71], v3, s[16:19], s49 offen offset:256 nt
    buffer_load_dwordx4 v[72:75], v3, s[16:19], s49 offen offset:512 nt
    buffer_load_dwordx4 v[76:79], v3, s[16:19], s49 offen offset:768 nt
    s_cmp_ge_u32 s5, 30
    s_cbranch_scc1 L_D
    s_cmp_ge_u32 s5, 16
    s_cbranch_scc1 L_G
    s_lshl_b32 s51, s4, 19
    s_and_b32 s7, s5, 1
    s_lshl_b32 s7, s7, 3
    s_add_u32 s7, s7, s3
    s_lshl_b32 s7, s7, 15
    s_add_u32 s51, s51, s7
    s_bfe_u32 s7, s5, 0x30001
    s_xor_b32 s7, s7, 4
    s_lshl_b32 s7, s7, 7
    s_add_u32 s51, s51, s7
    s_add_u32 s52, s51, 16384
    s_lshl_b32 s54, s3, 12
    s_add_u32 s55, s54, 2048
    s_and_b32 s7, s5, 7
    s_lshl_b32 s62, s7, 10
    s_and_b32 s7, s3, 3
    s_lshl_b32 s7, s7, 8
    s_add_u32 s62, s62, s7
    v_and_b32 v6, 31, v1
    v_lshlrev_b32 v6, 3, v6
    v_lshrrev_b32 v113, 5, v1
    v_lshl_add_u32 v6, v113, 2, v6
    v_lshrrev_b32 v113, 3, v1
    v_and_b32 v114, 7, v1
    v_and_b32 v115, 2, v113
    v_xor_b32 v114, v114, v115
    v_lshlrev_b32 v114, 4, v114
    v_lshl_add_u32 v113, v113, 10, v114
    v_xor_b32 v114, 64, v113
    s_bfe_u32 s7, s51, 0x30007
    s_cmp_eq_u32 s7, 3
    s_cselect_b64 s[0:1], -1, 0
    s_barrier
    ds_read_b128 v[104:107], v13
    v_mov_b32 v110, 143744
    ds_read_b32 v108, v110
    s_waitcnt vmcnt(8) lgkmcnt(0)
    v_mfma_f32_16x16x32_bf16 v[96:99], v[16:19], v[104:107], 0
    v_mfma_f32_16x16x32_bf16 v[16:19], v[20:23], v[104:107], 0
    v_mfma_f32_16x16x32_bf16 v[20:23], v[24:27], v[104:107], 0
    v_mfma_f32_16x16x32_bf16 v[24:27], v[28:31], v[104:107], 0
    v_mfma_f32_16x16x32_bf16 v[28:31], v[32:35], v[104:107], 0
    v_mfma_f32_16x16x32_bf16 v[32:35], v[36:39], v[104:107], 0
    v_mfma_f32_16x16x32_bf16 v[36:39], v[40:43], v[104:107], 0
    v_mfma_f32_16x16x32_bf16 v[40:43], v[44:47], v[104:107], 0
    s_nop 0
    v_add_f32_dpp v96, v97, v96 row_ror:12 row_mask:0xf bank_mask:0xf
    v_add_f32_dpp v17, v18, v17 row_ror:12 row_mask:0xf bank_mask:0xf
    v_add_f32_dpp v22, v23, v22 row_ror:12 row_mask:0xf bank_mask:0xf
    v_add_f32_dpp v27, v24, v27 row_ror:12 row_mask:0xf bank_mask:0xf
    v_add_f32_dpp v28, v29, v28 row_ror:12 row_mask:0xf bank_mask:0xf
    v_add_f32_dpp v33, v34, v33 row_ror:12 row_mask:0xf bank_mask:0xf
    v_add_f32_dpp v38, v39, v38 row_ror:12 row_mask:0xf bank_mask:0xf
    v_add_f32_dpp v43, v40, v43 row_ror:12 row_mask:0xf bank_mask:0xf
    v_readfirstlane_b32 s97, v108
    v_add_f32_dpp v96, v98, v96 row_ror:8 row_mask:0xf bank_mask:0xf
    v_add_f32_dpp v28, v30, v28 row_ror:8 row_mask:0xf bank_mask:0xf
    v_add_f32_dpp v17, v19, v17 row_ror:8 row_mask:0xf bank_mask:0xf
    v_add_f32_dpp v33, v35, v33 row_ror:8 row_mask:0xf bank_mask:0xf
    v_add_f32_dpp v100, v99, v96 row_ror:4 row_mask:0xf bank_mask:0x1
    v_add_f32_dpp v22, v20, v22 row_ror:8 row_mask:0xf bank_mask:0xf
    v_add_f32_dpp v101, v31, v28 row_ror:4 row_mask:0xf bank_mask:0x1
    v_add_f32_dpp v38, v36, v38 row_ror:8 row_mask:0xf bank_mask:0xf
    v_add_f32_dpp v100, v16, v17 row_ror:4 row_mask:0xf bank_mask:0x2
    v_add_f32_dpp v27, v25, v27 row_ror:8 row_mask:0xf bank_mask:0xf
    v_add_f32_dpp v101, v32, v33 row_ror:4 row_mask:0xf bank_mask:0x2
    v_add_f32_dpp v43, v41, v43 row_ror:8 row_mask:0xf bank_mask:0xf
    v_add_f32_dpp v100, v21, v22 row_ror:4 row_mask:0xf bank_mask:0x4
    v_add_f32_dpp v101, v37, v38 row_ror:4 row_mask:0xf bank_mask:0x4
    s_nop 0
    v_add_f32_dpp v100, v26, v27 row_ror:4 row_mask:0xf bank_mask:0x8
    v_add_f32_dpp v101, v42, v43 row_ror:4 row_mask:0xf bank_mask:0x8
    v_cvt_pk_bf16_f32 v102, v100, v101
    v_lshlrev_b32 v100, 16, v102
    v_and_b32 v101, s56, v102
    v_mul_f32 v100, s57, v100
    v_mul_f32 v101, s57, v101
    v_cvt_pk_bf16_f32 v102, v100, v101
    v_lshlrev_b32 v100, 16, v102
    v_and_b32 v101, s56, v102
    v_max_f32 v102, v100, v101
    s_nop 1
    v_max_f32_dpp v102, v102, v102 row_ror:4 row_mask:0xf bank_mask:0xf
    s_nop 1
    v_max_f32_dpp v102, v102, v102 row_ror:8 row_mask:0xf bank_mask:0xf
    v_mov_b32 v103, v102
    s_nop 1
    v_permlane16_swap_b32 v102, v103
    v_max_f32 v102, v102, v103
    v_mov_b32 v103, v102
    s_nop 1
    v_permlane32_swap_b32 v102, v103
    v_max_f32 v102, v102, v103
    ds_write_b32 v9, v102
    s_waitcnt lgkmcnt(0)
    s_barrier
    ds_read_b128 v[104:107], v12
    ds_read_b128 v[108:111], v12 offset:16
    s_waitcnt lgkmcnt(0)
    v_max3_f32 v102, v104, v105, v106
    v_max3_f32 v103, v107, v108, v109
    v_max3_f32 v102, v102, v110, v111
    v_max_f32 v104, v102, v103
    v_sub_f32 v100, v100, v104
    v_sub_f32 v101, v101, v104
    v_mul_f32 v100, s58, v100
    v_mul_f32 v101, s58, v101
    v_exp_f32 v100, v100
    v_exp_f32 v101, v101
    v_readlane_b32 s101, v104, s3
    v_cvt_pk_bf16_f32 v105, v100, v101
    v_add_f32 v102, v100, v101
    s_nop 1
    v_add_f32_dpp v102, v102, v102 row_ror:4 row_mask:0xf bank_mask:0xf
    s_nop 1
    v_add_f32_dpp v102, v102, v102 row_ror:8 row_mask:0xf bank_mask:0xf
    v_mov_b32 v103, v102
    s_nop 1
    v_permlane16_swap_b32 v102, v103
    v_add_f32 v102, v102, v103
    v_mov_b32 v103, v102
    s_nop 1
    v_permlane32_swap_b32 v102, v103
    v_add_f32 v102, v102, v103
    ds_write_b32 v9, v102 offset:128
    v_mov_b32_dpp v80, v105 quad_perm:[0,1,2,3] row_mask:0xf bank_mask:0x1
    v_mov_b32_dpp v81, v105 row_ror:12 row_mask:0xf bank_mask:0x1
    v_mov_b32_dpp v82, v105 row_ror:8 row_mask:0xf bank_mask:0x1
    v_mov_b32_dpp v83, v105 row_ror:4 row_mask:0xf bank_mask:0x1
    v_mov_b32_dpp v84, v105 row_ror:4 row_mask:0xf bank_mask:0x2
    v_mov_b32_dpp v85, v105 quad_perm:[0,1,2,3] row_mask:0xf bank_mask:0x2
    v_mov_b32_dpp v86, v105 row_ror:12 row_mask:0xf bank_mask:0x2
    v_mov_b32_dpp v87, v105 row_ror:8 row_mask:0xf bank_mask:0x2
    v_mov_b32_dpp v88, v105 row_ror:8 row_mask:0xf bank_mask:0x4
    v_mov_b32_dpp v89, v105 row_ror:4 row_mask:0xf bank_mask:0x4
    v_mov_b32_dpp v90, v105 quad_perm:[0,1,2,3] row_mask:0xf bank_mask:0x4
    v_mov_b32_dpp v91, v105 row_ror:12 row_mask:0xf bank_mask:0x4
    v_mov_b32_dpp v92, v105 row_ror:12 row_mask:0xf bank_mask:0x8
    v_mov_b32_dpp v93, v105 row_ror:8 row_mask:0xf bank_mask:0x8
    v_mov_b32_dpp v94, v105 row_ror:4 row_mask:0xf bank_mask:0x8
    v_mov_b32_dpp v95, v105 quad_perm:[0,1,2,3] row_mask:0xf bank_mask:0x8
    s_not_b64 exec, s[0:1]
    s_mov_b32 m0, s54
    s_nop 0
    buffer_load_dwordx4 v113, s[24:27], s51 offen nt lds
    s_add_u32 m0, s54, 1024
    s_add_u32 s7, s51, 8192
    buffer_load_dwordx4 v114, s[24:27], s7 offen nt lds
    s_mov_b64 exec, -1
    s_not_b64 exec, s[0:1]
    s_mov_b32 m0, s55
    s_nop 0
    buffer_load_dwordx4 v113, s[24:27], s52 offen nt lds
    s_add_u32 m0, s55, 1024
    s_add_u32 s7, s52, 8192
    buffer_load_dwordx4 v114, s[24:27], s7 offen nt lds
    s_mov_b64 exec, -1
    v_bfe_u32 v116, v1, 2, 2
    v_and_b32 v117, 3, v1
    v_lshlrev_b32 v14, 10, v11
    v_lshl_add_u32 v14, v116, 7, v14
    v_lshl_add_u32 v14, v117, 3, v14
    v_lshrrev_b32 v116, 1, v116
    v_lshl_add_u32 v14, v116, 5, v14
    v_and_b32 v116, 1, v11
    v_lshl_add_u32 v14, v116, 6, v14
    v_add_u32 v14, s54, v14
    v_xor_b32 v3, 32, v14
    v_xor_b32 v116, 64, v14
    v_xor_b32 v117, 64, v3
    s_and_b32 s7, s5, 1
    s_lshl_b32 s7, s7, 3
    s_add_u32 s7, s7, s3
    s_lshr_b32 s63, s7, 2
    s_lshl_b32 s63, s63, 7
    s_add_u32 s63, s63, s6
    s_add_u32 s63, s63, 41984
    s_lshl_b32 s61, s7, 6
    s_lshr_b32 s7, s7, 1
    s_lshl_b32 s48, s7, 12
    s_add_u32 s48, s48, s6
    s_and_b32 s7, s3, 1
    s_lshl_b32 s7, s7, 10
    s_add_u32 s48, s48, s7
    v_lshlrev_b32 v2, 3, v10
    v_add_u32 v115, -16352, v15
    s_lshl_b32 s7, s3, 11
    s_add_u32 s7, s7, 115968
    v_add_u32 v12, s7, v8
    v_add_u32 v13, 1024, v12
    s_lshl_b32 s7, s3, 9
    s_add_u32 s7, s7, 115968
    v_and_b32 v106, 3, v1
    v_lshrrev_b32 v107, 2, v1
    v_lshlrev_b32 v104, 3, v107
    v_lshl_add_u32 v104, v106, 7, v104
    v_add_u32 v104, s7, v104
    s_lshl_b32 s7, s3, 5
    s_add_u32 s7, s7, 115840
    v_mov_b32 v105, s7
    v_and_b32 v9, 7, v107
    v_lshlrev_b32 v9, 8, v9
    v_lshl_add_u32 v9, v106, 2, v9
    v_lshrrev_b32 v107, 5, v1
    v_lshl_add_u32 v9, v107, 12, v9
    s_waitcnt vmcnt(10)
    v_perm_b32 v16, v52, v48, s59
    v_perm_b32 v20, v52, v48, s60
    v_perm_b32 v24, v53, v49, s59
    v_perm_b32 v28, v53, v49, s60
    v_perm_b32 v32, v54, v50, s59
    v_perm_b32 v36, v54, v50, s60
    v_perm_b32 v40, v55, v51, s59
    v_perm_b32 v44, v55, v51, s60
    s_waitcnt vmcnt(8)
    v_perm_b32 v17, v60, v56, s59
    v_perm_b32 v21, v60, v56, s60
    v_perm_b32 v25, v61, v57, s59
    v_perm_b32 v29, v61, v57, s60
    v_perm_b32 v33, v62, v58, s59
    v_perm_b32 v37, v62, v58, s60
    v_perm_b32 v41, v63, v59, s59
    v_perm_b32 v45, v63, v59, s60
    s_waitcnt vmcnt(6)
    v_perm_b32 v18, v68, v64, s59
    v_perm_b32 v22, v68, v64, s60
    v_perm_b32 v26, v69, v65, s59
    v_perm_b32 v30, v69, v65, s60
    v_perm_b32 v34, v70, v66, s59
    v_perm_b32 v38, v70, v66, s60
    v_perm_b32 v42, v71, v67, s59
    v_perm_b32 v46, v71, v67, s60
    s_waitcnt vmcnt(4)
    v_perm_b32 v19, v76, v72, s59
    v_perm_b32 v23, v76, v72, s60
    v_perm_b32 v27, v77, v73, s59
    v_perm_b32 v31, v77, v73, s60
    v_perm_b32 v35, v78, v74, s59
    v_perm_b32 v39, v78, v74, s60
    v_perm_b32 v43, v79, v75, s59
    v_perm_b32 v47, v79, v75, s60
    v_mfma_f32_16x16x32_bf16 v[96:99], v[80:83], v[16:19], 0
    v_mfma_f32_16x16x32_bf16 v[100:103], v[80:83], v[20:23], 0
    v_mfma_f32_16x16x32_bf16 v[96:99], v[84:87], v[24:27], v[96:99]
    v_mfma_f32_16x16x32_bf16 v[100:103], v[84:87], v[28:31], v[100:103]
    v_mfma_f32_16x16x32_bf16 v[96:99], v[88:91], v[32:35], v[96:99]
    v_mfma_f32_16x16x32_bf16 v[100:103], v[88:91], v[36:39], v[100:103]
    v_mfma_f32_16x16x32_bf16 v[96:99], v[92:95], v[40:43], v[96:99]
    v_mfma_f32_16x16x32_bf16 v[100:103], v[92:95], v[44:47], v[100:103]
    s_nop 7
    ds_write2_b32 v12, v96, v100 offset0:0 offset1:1
    ds_write2_b32 v12, v97, v101 offset0:128 offset1:129
    ds_write2_b32 v13, v98, v102 offset0:0 offset1:1
    ds_write2_b32 v13, v99, v103 offset0:128 offset1:129
    s_waitcnt lgkmcnt(0)
    s_barrier
    s_cmp_ge_u32 s3, 4
    s_cbranch_scc1 L_pub_doneW
    ds_read_b128 v[96:99], v105
    ds_read_b128 v[100:103], v105 offset:16
    ds_read_b64 v[16:17], v104 offset:0
    ds_read_b64 v[18:19], v104 offset:2048
    ds_read_b64 v[20:21], v104 offset:4096
    ds_read_b64 v[22:23], v104 offset:6144
    ds_read_b64 v[24:25], v104 offset:8192
    ds_read_b64 v[26:27], v104 offset:10240
    ds_read_b64 v[28:29], v104 offset:12288
    ds_read_b64 v[30:31], v104 offset:14336
    s_waitcnt lgkmcnt(8)
    v_pk_add_f32 v[96:97], v[96:97], v[98:99]
    v_pk_add_f32 v[100:101], v[100:101], v[102:103]
    v_pk_add_f32 v[96:97], v[96:97], v[100:101]
    v_add_f32 v96, v96, v97
    v_rcp_f32 v97, v96
    v_log_f32 v98, v96
    s_waitcnt lgkmcnt(0)
    v_pk_add_f32 v[16:17], v[16:17], v[18:19]
    v_pk_add_f32 v[20:21], v[20:21], v[22:23]
    v_pk_add_f32 v[24:25], v[24:25], v[26:27]
    v_pk_add_f32 v[28:29], v[28:29], v[30:31]
    v_pk_add_f32 v[16:17], v[16:17], v[20:21]
    v_pk_add_f32 v[24:25], v[24:25], v[28:29]
    v_pk_add_f32 v[16:17], v[16:17], v[24:25]
    v_mul_f32 v16, v16, v97
    v_mul_f32 v17, v17, v97
    v_cvt_pk_bf16_f32 v16, v16, v17
    v_mov_b32 v99, s101
    v_fmac_f32 v98, s58, v99
    v_min_u32 v16, -2, v16
    v_min_u32 v98, -2, v98
    buffer_store_dword v16, v9, s[40:43], s98 offen
    s_mov_b64 exec, 1
    buffer_store_dword v98, off, s[40:43], s99
    s_mov_b64 exec, -1
    s_cmp_eq_u32 s97, 0
    s_cbranch_scc1 L_pub_doneW
    s_lshl_b32 s7, s5, 10
    s_add_u32 s7, s7, s6
    s_lshl_b32 s49, s3, 8
    s_add_u32 s7, s7, s49
    s_add_u32 s7, s7, 65536
    s_add_u32 s49, s99, 65536
    v_lshlrev_b32 v4, 2, v1
    buffer_store_dword v98, off, s[40:43], s49 sc1
    buffer_store_dword v16, v4, s[40:43], s7 offen sc1
L_pub_doneW:
    s_barrier
    s_mov_b64 exec, s[0:1]
    s_mov_b32 m0, s54
    s_nop 0
    buffer_load_dwordx4 v113, s[24:27], s51 offen nt lds
    s_add_u32 m0, s54, 1024
    s_add_u32 s7, s51, 8192
    buffer_load_dwordx4 v114, s[24:27], s7 offen nt lds
    s_mov_b64 exec, -1
    s_mov_b64 exec, s[0:1]
    s_mov_b32 m0, s55
    s_nop 0
    buffer_load_dwordx4 v113, s[24:27], s52 offen nt lds
    s_add_u32 m0, s55, 1024
    s_add_u32 s7, s52, 8192
    buffer_load_dwordx4 v114, s[24:27], s7 offen nt lds
    s_mov_b64 exec, -1
    buffer_load_dwordx2 v[32:33], v2, s[40:43], s63 offen sc1
    buffer_load_dwordx4 v[16:19], v7, s[40:43], s48 offen offset:0 sc1
    buffer_load_dwordx4 v[20:23], v7, s[40:43], s48 offen offset:2048 sc1
    v_and_b32 v9, 7, v10
    v_lshrrev_b32 v13, 3, v10
    v_lshl_add_u32 v13, v9, 1, v13
    v_lshlrev_b32 v12, 11, v13
    v_lshl_add_u32 v12, v11, 4, v12
    s_add_u32 s49, s6, s61
    s_add_u32 s49, s49, 65536
    s_add_u32 s55, s63, 65536
    s_waitcnt vmcnt(3)
    ds_read_b64_tr_b16 v[48:49], v14 offset:0
    ds_read_b64_tr_b16 v[50:51], v14 offset:512
    ds_read_b64_tr_b16 v[52:53], v3 offset:0
    ds_read_b64_tr_b16 v[54:55], v3 offset:512
    ds_read_b64_tr_b16 v[56:57], v116 offset:0
    ds_read_b64_tr_b16 v[58:59], v116 offset:512
    ds_read_b64_tr_b16 v[60:61], v117 offset:0
    ds_read_b64_tr_b16 v[62:63], v117 offset:512
    s_cmp_eq_u32 s97, 0
    s_cselect_b32 s49, s48, s49
    s_cselect_b32 s7, 2, 1
    s_cselect_b32 s63, s63, s55
    s_cselect_b64 vcc, -1, 0
    v_cndmask_b32 v12, v12, v7, vcc
    s_lshl_b32 s7, s7, 10
    s_add_u32 s48, s49, s7
    s_cmp_eq_u32 s97, 0
    s_cbranch_scc1 L_w_f
    s_waitcnt vmcnt(0)
    v_mov_b32 v32, -1
    s_mov_b64 vcc, -1
    buffer_load_dwordx2 v[32:33], v2, s[40:43], s63 offen sc1
    buffer_load_dwordx4 v[16:19], v12, s[40:43], s49 offen sc1
    buffer_load_dwordx4 v[20:23], v12, s[40:43], s48 offen sc1
L_w_f:
    s_branch L_w_c
L_w_poll:
    s_mov_b64 exec, vcc
    s_sub_u32 s96, s96, 1
    s_cbranch_scc1 L_end
    buffer_load_dwordx2 v[32:33], v2, s[40:43], s63 offen sc1
    buffer_load_dwordx4 v[16:19], v12, s[40:43], s49 offen sc1
    buffer_load_dwordx4 v[20:23], v12, s[40:43], s48 offen sc1
    s_mov_b64 exec, -1
L_w_c:
    s_waitcnt vmcnt(0)
    v_max3_u32 v37, v16, v17, v18
    v_max3_u32 v37, v37, v19, v20
    v_max3_u32 v37, v37, v21, v22
    v_max3_u32 v37, v37, v23, v32
    v_max_u32 v37, v37, v33
    v_cmp_eq_u32 vcc, -1, v37
    s_cbranch_vccnz L_w_poll
    s_waitcnt lgkmcnt(0)
    v_mfma_f32_16x16x32_bf16 v[64:67], v[48:51], v[16:19], 0
    v_mfma_f32_16x16x32_bf16 v[72:75], v[52:55], v[16:19], 0
    v_mfma_f32_16x16x32_bf16 v[80:83], v[56:59], v[16:19], 0
    v_mfma_f32_16x16x32_bf16 v[88:91], v[60:63], v[16:19], 0
    v_max_f32 v36, v32, v33
    v_mfma_f32_16x16x32_bf16 v[68:71], v[48:51], v[20:23], 0
    v_mfma_f32_16x16x32_bf16 v[76:79], v[52:55], v[20:23], 0
    v_max_f32_dpp v36, v36, v36 row_ror:8 row_mask:0xf bank_mask:0xf
    v_sub_f32 v34, v32, v36
    v_sub_f32 v35, v33, v36
    v_exp_f32 v34, v34
    v_exp_f32 v35, v35
    v_mfma_f32_16x16x32_bf16 v[84:87], v[56:59], v[20:23], 0
    v_mfma_f32_16x16x32_bf16 v[92:95], v[60:63], v[20:23], 0
    v_add_f32 v36, v34, v35
    s_nop 1
    v_add_f32_dpp v36, v36, v36 row_ror:8 row_mask:0xf bank_mask:0xf
    v_rcp_f32 v36, v36
    s_nop 0
    v_mul_f32 v34, v34, v36
    v_mul_f32 v38, v35, v36
    v_pk_mul_f32 v[64:65], v[64:65], v[34:35] op_sel_hi:[1,0]
    v_pk_mul_f32 v[66:67], v[66:67], v[34:35] op_sel_hi:[1,0]
    v_pk_mul_f32 v[80:81], v[80:81], v[34:35] op_sel_hi:[1,0]
    v_pk_mul_f32 v[82:83], v[82:83], v[34:35] op_sel_hi:[1,0]
    v_pk_fma_f32 v[64:65], v[68:69], v[38:39], v[64:65] op_sel_hi:[1,0,1]
    v_pk_fma_f32 v[66:67], v[70:71], v[38:39], v[66:67] op_sel_hi:[1,0,1]
    v_pk_fma_f32 v[80:81], v[84:85], v[38:39], v[80:81] op_sel_hi:[1,0,1]
    v_pk_fma_f32 v[82:83], v[86:87], v[38:39], v[82:83] op_sel_hi:[1,0,1]
    v_add_f32_dpp v64, v64, v64 row_ror:8 row_mask:0xf bank_mask:0x3
    v_add_f32_dpp v65, v65, v65 row_ror:8 row_mask:0xf bank_mask:0x3
    v_add_f32_dpp v66, v66, v66 row_ror:8 row_mask:0xf bank_mask:0x3
    v_add_f32_dpp v67, v67, v67 row_ror:8 row_mask:0xf bank_mask:0x3
    v_add_f32_dpp v64, v80, v80 row_ror:8 row_mask:0xf bank_mask:0xc
    v_add_f32_dpp v65, v81, v81 row_ror:8 row_mask:0xf bank_mask:0xc
    v_add_f32_dpp v66, v82, v82 row_ror:8 row_mask:0xf bank_mask:0xc
    v_add_f32_dpp v67, v83, v83 row_ror:8 row_mask:0xf bank_mask:0xc
    ds_write_b128 v15, v[64:67]
    v_pk_mul_f32 v[72:73], v[72:73], v[34:35] op_sel_hi:[1,0]
    v_pk_mul_f32 v[74:75], v[74:75], v[34:35] op_sel_hi:[1,0]
    v_pk_mul_f32 v[88:89], v[88:89], v[34:35] op_sel_hi:[1,0]
    v_pk_mul_f32 v[90:91], v[90:91], v[34:35] op_sel_hi:[1,0]
    v_pk_fma_f32 v[72:73], v[76:77], v[38:39], v[72:73] op_sel_hi:[1,0,1]
    v_pk_fma_f32 v[74:75], v[78:79], v[38:39], v[74:75] op_sel_hi:[1,0,1]
    v_pk_fma_f32 v[88:89], v[92:93], v[38:39], v[88:89] op_sel_hi:[1,0,1]
    v_pk_fma_f32 v[90:91], v[94:95], v[38:39], v[90:91] op_sel_hi:[1,0,1]
    v_add_f32_dpp v72, v72, v72 row_ror:8 row_mask:0xf bank_mask:0x3
    v_add_f32_dpp v73, v73, v73 row_ror:8 row_mask:0xf bank_mask:0x3
    v_add_f32_dpp v74, v74, v74 row_ror:8 row_mask:0xf bank_mask:0x3
    v_add_f32_dpp v75, v75, v75 row_ror:8 row_mask:0xf bank_mask:0x3
    v_add_f32_dpp v72, v88, v88 row_ror:8 row_mask:0xf bank_mask:0xc
    v_add_f32_dpp v73, v89, v89 row_ror:8 row_mask:0xf bank_mask:0xc
    v_add_f32_dpp v74, v90, v90 row_ror:8 row_mask:0xf bank_mask:0xc
    v_add_f32_dpp v75, v91, v91 row_ror:8 row_mask:0xf bank_mask:0xc
    ds_write_b128 v115, v[72:75]
    s_waitcnt lgkmcnt(0)
    s_barrier
    s_cmp_ge_u32 s5, 8
    s_cbranch_scc1 L_kv_end
    s_cmp_ge_u32 s3, 4
    s_cbranch_scc1 L_kv_end
    s_lshl_b32 s52, s62, 1
    s_add_u32 s52, s52, 1310720
    s_add_u32 s100, s100, 1
    s_and_b32 s100, s100, 0xff
    buffer_load_dword v112, v6, s[8:11], s62 offen
    s_and_b32 s7, s5, 4
    s_add_u32 s7, s7, s3
    s_lshl_b32 s48, s7, 10
    s_and_b32 s7, s5, 3
    s_lshl_b32 s7, s7, 4
    s_add_u32 s48, s48, s7
    s_add_u32 s48, s48, s6
    s_add_u32 s48, s48, 32768
    v_lshrrev_b32 v9, 4, v6
    v_lshlrev_b32 v9, 6, v9
    v_and_b32 v5, 12, v6
    v_add_u32 v9, v5, v9
    v_and_b32 v5, 31, v1
    v_lshlrev_b32 v5, 4, v5
    v_lshrrev_b32 v4, 5, v1
    v_lshl_add_u32 v5, v4, 14, v5
    s_add_u32 s49, s62, s6
    s_add_u32 s49, s49, 98304
    s_lshl_b32 s7, s5, 7
    s_add_u32 s54, s6, s7
    s_add_u32 s54, s54, 40960
    s_and_b32 s7, s4, 1
    s_lshl_b32 s7, s7, 7
    s_sub_u32 s54, s54, s7
    s_xor_b32 s55, s54, 65536
    s_bitcmp1_b32 s4, 0
    s_cselect_b32 s58, s56, 0xffff
    s_mov_b32 s59, s58
    s_lshl_b32 s7, s3, 3
    s_add_u32 s7, s7, 115712
    v_mov_b32 v12, s7
    v_mov_b32 v13, 115712
    s_cmp_lg_u32 s97, 0
    s_cbranch_scc1 L_rg_x
    s_add_u32 s51, s6, 43008
    v_min_u32 v122, 15, v1
    v_lshlrev_b32 v122, 2, v122
L_rg:
    s_sub_u32 s96, s96, 1
    s_cbranch_scc1 L_end
    buffer_load_dword v123, v122, s[40:43], s51 offen sc1
    s_waitcnt vmcnt(0)
    v_cmp_eq_u32 vcc, -1, v123
    s_cbranch_vccnz L_rg
L_rg_x:
    s_waitcnt vmcnt(0)
    v_lshlrev_b32 v120, 16, v112
    v_and_b32 v121, s56, v112
    s_mov_b32 s51, s52
    buffer_load_dwordx4 v[16:19], v5, s[40:43], s51 offen sc1
    s_add_u32 s51, s51, 32768
    buffer_load_dwordx4 v[20:23], v5, s[40:43], s51 offen sc1
    s_add_u32 s51, s51, 32768
    buffer_load_dwordx4 v[24:27], v5, s[40:43], s51 offen sc1
    s_add_u32 s51, s51, 32768
    buffer_load_dwordx4 v[28:31], v5, s[40:43], s51 offen sc1
    s_add_u32 s51, s51, 32768
    buffer_load_dwordx4 v[32:35], v5, s[40:43], s51 offen sc1
    s_add_u32 s51, s51, 32768
    buffer_load_dwordx4 v[36:39], v5, s[40:43], s51 offen sc1
    s_add_u32 s51, s51, 32768
    buffer_load_dwordx4 v[40:43], v5, s[40:43], s51 offen sc1
    s_add_u32 s51, s51, 32768
    buffer_load_dwordx4 v[44:47], v5, s[40:43], s51 offen sc1
    s_branch L_r_poll_c
L_r_poll:
    s_wqm_b64 exec, vcc
    s_sub_u32 s96, s96, 1
    s_cbranch_scc1 L_end
    s_mov_b32 s51, s52
    buffer_load_dwordx4 v[16:19], v5, s[40:43], s51 offen sc1
    s_add_u32 s51, s51, 32768
    buffer_load_dwordx4 v[20:23], v5, s[40:43], s51 offen sc1
    s_add_u32 s51, s51, 32768
    buffer_load_dwordx4 v[24:27], v5, s[40:43], s51 offen sc1
    s_add_u32 s51, s51, 32768
    buffer_load_dwordx4 v[28:31], v5, s[40:43], s51 offen sc1
    s_add_u32 s51, s51, 32768
    buffer_load_dwordx4 v[32:35], v5, s[40:43], s51 offen sc1
    s_add_u32 s51, s51, 32768
    buffer_load_dwordx4 v[36:39], v5, s[40:43], s51 offen sc1
    s_add_u32 s51, s51, 32768
    buffer_load_dwordx4 v[40:43], v5, s[40:43], s51 offen sc1
    s_add_u32 s51, s51, 32768
    buffer_load_dwordx4 v[44:47], v5, s[40:43], s51 offen sc1
    s_mov_b64 exec, -1
L_r_poll_c:
    s_waitcnt vmcnt(7)
    v_xor_b32 v48, s100, v16
    v_xor_b32 v49, s100, v17
    v_xor_b32 v50, s100, v18
    v_xor_b32 v51, s100, v19
    v_or3_b32 v102, v48, v49, v50
    v_or_b32 v102, v102, v51
    s_waitcnt vmcnt(6)
    v_xor_b32 v52, s100, v20
    v_xor_b32 v53, s100, v21
    v_xor_b32 v54, s100, v22
    v_xor_b32 v55, s100, v23
    v_or3_b32 v102, v102, v52, v53
    v_or3_b32 v102, v102, v54, v55
    v_pk_add_f32 v[96:97], v[48:49], v[52:53]
    v_pk_add_f32 v[98:99], v[50:51], v[54:55]
    s_waitcnt vmcnt(5)
    v_xor_b32 v56, s100, v24
    v_xor_b32 v57, s100, v25
    v_xor_b32 v58, s100, v26
    v_xor_b32 v59, s100, v27
    v_or3_b32 v102, v102, v56, v57
    v_or3_b32 v102, v102, v58, v59
    v_pk_add_f32 v[96:97], v[96:97], v[56:57]
    v_pk_add_f32 v[98:99], v[98:99], v[58:59]
    s_waitcnt vmcnt(4)
    v_xor_b32 v60, s100, v28
    v_xor_b32 v61, s100, v29
    v_xor_b32 v62, s100, v30
    v_xor_b32 v63, s100, v31
    v_or3_b32 v102, v102, v60, v61
    v_or3_b32 v102, v102, v62, v63
    v_pk_add_f32 v[96:97], v[96:97], v[60:61]
    v_pk_add_f32 v[98:99], v[98:99], v[62:63]
    s_waitcnt vmcnt(3)
    v_xor_b32 v64, s100, v32
    v_xor_b32 v65, s100, v33
    v_xor_b32 v66, s100, v34
    v_xor_b32 v67, s100, v35
    v_or3_b32 v102, v102, v64, v65
    v_or3_b32 v102, v102, v66, v67
    v_pk_add_f32 v[96:97], v[96:97], v[64:65]
    v_pk_add_f32 v[98:99], v[98:99], v[66:67]
    s_waitcnt vmcnt(2)
    v_xor_b32 v68, s100, v36
    v_xor_b32 v69, s100, v37
    v_xor_b32 v70, s100, v38
    v_xor_b32 v71, s100, v39
    v_or3_b32 v102, v102, v68, v69
    v_or3_b32 v102, v102, v70, v71
    v_pk_add_f32 v[96:97], v[96:97], v[68:69]
    v_pk_add_f32 v[98:99], v[98:99], v[70:71]
    s_waitcnt vmcnt(1)
    v_xor_b32 v72, s100, v40
    v_xor_b32 v73, s100, v41
    v_xor_b32 v74, s100, v42
    v_xor_b32 v75, s100, v43
    v_or3_b32 v102, v102, v72, v73
    v_or3_b32 v102, v102, v74, v75
    v_pk_add_f32 v[96:97], v[96:97], v[72:73]
    v_pk_add_f32 v[98:99], v[98:99], v[74:75]
    s_waitcnt vmcnt(0)
    v_xor_b32 v76, s100, v44
    v_xor_b32 v77, s100, v45
    v_xor_b32 v78, s100, v46
    v_xor_b32 v79, s100, v47
    v_or3_b32 v102, v102, v76, v77
    v_or3_b32 v102, v102, v78, v79
    v_pk_add_f32 v[96:97], v[96:97], v[76:77]
    v_pk_add_f32 v[98:99], v[98:99], v[78:79]
    s_nop 1
    v_permlane32_swap_b32 v96, v98
    v_permlane32_swap_b32 v97, v99
    v_and_b32 v102, 0xff, v102
    v_cmp_ne_u32 vcc, 0, v102
    v_pk_add_f32 v[96:97], v[96:97], v[98:99]
    v_cvt_pk_bf16_f32 v100, v96, v97
    v_lshlrev_b32 v96, 16, v100
    v_and_b32 v97, s56, v100
    s_cbranch_vccnz L_r_poll
    v_pk_add_f32 v[96:97], v[96:97], v[120:121]
    v_cvt_pk_bf16_f32 v100, v96, v97
    v_lshlrev_b32 v96, 16, v100
    v_and_b32 v97, s56, v100
    v_add_f32 v108, v96, v97
    v_mul_f32 v109, v96, v96
    v_fmac_f32 v109, v97, v97
    v_add_f32_dpp v108, v108, v108 quad_perm:[1,0,3,2] row_mask:0xf bank_mask:0xf
    s_nop 0
    v_add_f32_dpp v109, v109, v109 quad_perm:[1,0,3,2] row_mask:0xf bank_mask:0xf
    v_add_f32_dpp v108, v108, v108 quad_perm:[2,3,0,1] row_mask:0xf bank_mask:0xf
    s_nop 0
    v_add_f32_dpp v109, v109, v109 quad_perm:[2,3,0,1] row_mask:0xf bank_mask:0xf
    v_add_f32_dpp v108, v108, v108 row_half_mirror row_mask:0xf bank_mask:0xf
    s_nop 0
    v_add_f32_dpp v109, v109, v109 row_half_mirror row_mask:0xf bank_mask:0xf
    v_add_f32_dpp v108, v108, v108 row_mirror row_mask:0xf bank_mask:0xf
    s_nop 0
    v_add_f32_dpp v109, v109, v109 row_mirror row_mask:0xf bank_mask:0xf
    v_add_f32_dpp v108, v108, v108 row_bcast:15 row_mask:0xa bank_mask:0xf
    s_nop 0
    v_add_f32_dpp v109, v109, v109 row_bcast:15 row_mask:0xa bank_mask:0xf
    v_add_f32_dpp v108, v108, v108 row_bcast:31 row_mask:0xc bank_mask:0xf
    s_nop 0
    v_add_f32_dpp v109, v109, v109 row_bcast:31 row_mask:0xc bank_mask:0xf
    s_mov_b32 exec_lo, 0
    s_mov_b32 exec_hi, 0x80000000
    ds_write_b64 v12, v[108:109]
    s_mov_b64 exec, -1
    v_min_u32 v100, -2, v100
    s_waitcnt lgkmcnt(0)
    s_barrier
    ds_read_b128 v[104:107], v13
    ds_read_b128 v[108:111], v13 offset:16
    s_waitcnt lgkmcnt(0)
    v_pk_add_f32 v[104:105], v[104:105], v[106:107]
    v_pk_add_f32 v[108:109], v[108:109], v[110:111]
    v_pk_add_f32 v[104:105], v[104:105], v[108:109]
    v_mul_f32 v110, 0x3b000000, v104
    v_mul_f32 v111, 0x3b000000, v105
    v_fma_f32 v111, -v110, v110, v111
    v_max_f32 v111, 0, v111
    v_cvt_pk_bf16_f32 v110, v110, v111
    v_and_b32 v111, s56, v110
    v_lshlrev_b32 v110, 16, v110
    v_add_f32 v111, 0x3727c5ac, v111
    v_cvt_pk_bf16_f32 v111, v111, v111
    v_and_b32 v111, s56, v111
    v_sqrt_f32 v111, v111
    s_nop 0
    v_pk_add_f32 v[96:97], v[96:97], v[110:111] op_sel_hi:[1,0] neg_lo:[0,1] neg_hi:[0,1]
    v_cvt_pk_bf16_f32 v111, v111, v111
    v_and_b32 v111, s56, v111
    v_rcp_f32 v111, v111
    v_cvt_pk_bf16_f32 v101, v96, v97
    v_lshlrev_b32 v96, 16, v101
    v_and_b32 v97, s56, v101
    v_mul_f32 v96, v96, v111
    v_mul_f32 v97, v97, v111
    v_cvt_pk_bf16_f32 v101, v96, v97
    v_min_u32 v102, -2, v101
    v_min_u32 v103, -2, v101
    v_min_u32 v101, -2, v101
    s_nop 0
    v_permlane32_swap_b32 v102, v103
    s_mov_b32 exec_hi, 0
    buffer_store_dwordx2 v[102:103], v9, s[40:43], s48 offen
    s_mov_b64 exec, -1
    s_lshr_b32 s7, s4, 1
    s_cmp_lg_u32 s7, s3
    s_cbranch_scc1 L_r_noh
    s_mov_b64 exec, s[58:59]
    buffer_store_dword v100, v6, s[40:43], s54 offen
    s_cmp_eq_u32 s97, 0
    s_cbranch_scc1 L_r_noh
    buffer_store_dword v100, v6, s[40:43], s55 offen sc1
L_r_noh:
    s_mov_b64 exec, -1
    s_cmp_eq_u32 s97, 0
    s_cbranch_scc1 L_kv_end
    buffer_store_dword v101, v6, s[40:43], s49 offen sc1
    s_branch L_kv_end
L_G:
    s_sub_u32 s61, s5, 16
    s_mul_i32 s7, s4, 7
    s_lshr_b32 s62, s61, 1
    s_add_u32 s62, s62, s7
    s_mul_i32 s51, s53, 114688
    s_lshl_b32 s7, s62, 6
    s_add_u32 s51, s51, s7
    s_xor_b32 s7, s53, 1
    s_mul_i32 s52, s7, 114688
    s_lshl_b32 s7, s62, 6
    s_add_u32 s52, s52, s7
    s_lshl_b32 s54, s3, 13
    s_lshl_b32 s7, s50, 11
    s_add_u32 s54, s54, s7
    s_lshl_b32 s63, s62, 15
    s_lshl_b32 s7, s3, 7
    s_add_u32 s63, s63, s7
    s_bitcmp1_b32 s62, 0
    s_cbranch_scc0 L_t_nosw
    s_mov_b64 s[0:1], s[28:29]
    s_mov_b64 s[28:29], s[32:33]
    s_mov_b64 s[32:33], s[0:1]
    s_xor_b32 s54, s54, 4096
L_t_nosw:
    s_xor_b32 s55, s54, 2048
    v_lshrrev_b32 v113, 3, v1
    v_and_b32 v114, 7, v1
    v_and_b32 v115, 2, v113
    v_xor_b32 v114, v114, v115
    v_lshlrev_b32 v114, 4, v114
    v_lshl_add_u32 v113, v113, 10, v114
    v_xor_b32 v114, 64, v113
    s_and_b32 s7, s62, 6
    s_cmp_eq_u32 s7, 6
    s_cselect_b64 s[0:1], -1, 0
    s_barrier
    ds_read_b128 v[104:107], v13
    v_mov_b32 v110, 143744
    ds_read_b32 v108, v110
    s_waitcnt vmcnt(8) lgkmcnt(0)
    v_mfma_f32_16x16x32_bf16 v[96:99], v[16:19], v[104:107], 0
    v_mfma_f32_16x16x32_bf16 v[16:19], v[20:23], v[104:107], 0
    v_mfma_f32_16x16x32_bf16 v[20:23], v[24:27], v[104:107], 0
    v_mfma_f32_16x16x32_bf16 v[24:27], v[28:31], v[104:107], 0
    v_mfma_f32_16x16x32_bf16 v[28:31], v[32:35], v[104:107], 0
    v_mfma_f32_16x16x32_bf16 v[32:35], v[36:39], v[104:107], 0
    v_mfma_f32_16x16x32_bf16 v[36:39], v[40:43], v[104:107], 0
    v_mfma_f32_16x16x32_bf16 v[40:43], v[44:47], v[104:107], 0
    s_nop 0
    v_add_f32_dpp v96, v97, v96 row_ror:12 row_mask:0xf bank_mask:0xf
    v_add_f32_dpp v17, v18, v17 row_ror:12 row_mask:0xf bank_mask:0xf
    v_add_f32_dpp v22, v23, v22 row_ror:12 row_mask:0xf bank_mask:0xf
    v_add_f32_dpp v27, v24, v27 row_ror:12 row_mask:0xf bank_mask:0xf
    v_add_f32_dpp v28, v29, v28 row_ror:12 row_mask:0xf bank_mask:0xf
    v_add_f32_dpp v33, v34, v33 row_ror:12 row_mask:0xf bank_mask:0xf
    v_add_f32_dpp v38, v39, v38 row_ror:12 row_mask:0xf bank_mask:0xf
    v_add_f32_dpp v43, v40, v43 row_ror:12 row_mask:0xf bank_mask:0xf
    v_readfirstlane_b32 s97, v108
    v_add_f32_dpp v96, v98, v96 row_ror:8 row_mask:0xf bank_mask:0xf
    v_add_f32_dpp v28, v30, v28 row_ror:8 row_mask:0xf bank_mask:0xf
    v_add_f32_dpp v17, v19, v17 row_ror:8 row_mask:0xf bank_mask:0xf
    v_add_f32_dpp v33, v35, v33 row_ror:8 row_mask:0xf bank_mask:0xf
    v_add_f32_dpp v100, v99, v96 row_ror:4 row_mask:0xf bank_mask:0x1
    v_add_f32_dpp v22, v20, v22 row_ror:8 row_mask:0xf bank_mask:0xf
    v_add_f32_dpp v101, v31, v28 row_ror:4 row_mask:0xf bank_mask:0x1
    v_add_f32_dpp v38, v36, v38 row_ror:8 row_mask:0xf bank_mask:0xf
    v_add_f32_dpp v100, v16, v17 row_ror:4 row_mask:0xf bank_mask:0x2
    v_add_f32_dpp v27, v25, v27 row_ror:8 row_mask:0xf bank_mask:0xf
    v_add_f32_dpp v101, v32, v33 row_ror:4 row_mask:0xf bank_mask:0x2
    v_add_f32_dpp v43, v41, v43 row_ror:8 row_mask:0xf bank_mask:0xf
    v_add_f32_dpp v100, v21, v22 row_ror:4 row_mask:0xf bank_mask:0x4
    v_add_f32_dpp v101, v37, v38 row_ror:4 row_mask:0xf bank_mask:0x4
    s_nop 0
    v_add_f32_dpp v100, v26, v27 row_ror:4 row_mask:0xf bank_mask:0x8
    v_add_f32_dpp v101, v42, v43 row_ror:4 row_mask:0xf bank_mask:0x8
    v_cvt_pk_bf16_f32 v102, v100, v101
    v_lshlrev_b32 v100, 16, v102
    v_and_b32 v101, s56, v102
    v_mul_f32 v100, s57, v100
    v_mul_f32 v101, s57, v101
    v_cvt_pk_bf16_f32 v102, v100, v101
    v_lshlrev_b32 v100, 16, v102
    v_and_b32 v101, s56, v102
    v_max_f32 v102, v100, v101
    s_nop 1
    v_max_f32_dpp v102, v102, v102 row_ror:4 row_mask:0xf bank_mask:0xf
    s_nop 1
    v_max_f32_dpp v102, v102, v102 row_ror:8 row_mask:0xf bank_mask:0xf
    v_mov_b32 v103, v102
    s_nop 1
    v_permlane16_swap_b32 v102, v103
    v_max_f32 v102, v102, v103
    v_mov_b32 v103, v102
    s_nop 1
    v_permlane32_swap_b32 v102, v103
    v_max_f32 v102, v102, v103
    ds_write_b32 v9, v102
    s_waitcnt lgkmcnt(0)
    s_barrier
    ds_read_b128 v[104:107], v12
    ds_read_b128 v[108:111], v12 offset:16
    s_waitcnt lgkmcnt(0)
    v_max3_f32 v102, v104, v105, v106
    v_max3_f32 v103, v107, v108, v109
    v_max3_f32 v102, v102, v110, v111
    v_max_f32 v104, v102, v103
    v_sub_f32 v100, v100, v104
    v_sub_f32 v101, v101, v104
    v_mul_f32 v100, s58, v100
    v_mul_f32 v101, s58, v101
    v_exp_f32 v100, v100
    v_exp_f32 v101, v101
    v_readlane_b32 s101, v104, s3
    v_cvt_pk_bf16_f32 v105, v100, v101
    v_add_f32 v102, v100, v101
    s_nop 1
    v_add_f32_dpp v102, v102, v102 row_ror:4 row_mask:0xf bank_mask:0xf
    s_nop 1
    v_add_f32_dpp v102, v102, v102 row_ror:8 row_mask:0xf bank_mask:0xf
    v_mov_b32 v103, v102
    s_nop 1
    v_permlane16_swap_b32 v102, v103
    v_add_f32 v102, v102, v103
    v_mov_b32 v103, v102
    s_nop 1
    v_permlane32_swap_b32 v102, v103
    v_add_f32 v102, v102, v103
    ds_write_b32 v9, v102 offset:128
    v_mov_b32_dpp v80, v105 quad_perm:[0,1,2,3] row_mask:0xf bank_mask:0x1
    v_mov_b32_dpp v81, v105 row_ror:12 row_mask:0xf bank_mask:0x1
    v_mov_b32_dpp v82, v105 row_ror:8 row_mask:0xf bank_mask:0x1
    v_mov_b32_dpp v83, v105 row_ror:4 row_mask:0xf bank_mask:0x1
    v_mov_b32_dpp v84, v105 row_ror:4 row_mask:0xf bank_mask:0x2
    v_mov_b32_dpp v85, v105 quad_perm:[0,1,2,3] row_mask:0xf bank_mask:0x2
    v_mov_b32_dpp v86, v105 row_ror:12 row_mask:0xf bank_mask:0x2
    v_mov_b32_dpp v87, v105 row_ror:8 row_mask:0xf bank_mask:0x2
    v_mov_b32_dpp v88, v105 row_ror:8 row_mask:0xf bank_mask:0x4
    v_mov_b32_dpp v89, v105 row_ror:4 row_mask:0xf bank_mask:0x4
    v_mov_b32_dpp v90, v105 quad_perm:[0,1,2,3] row_mask:0xf bank_mask:0x4
    v_mov_b32_dpp v91, v105 row_ror:12 row_mask:0xf bank_mask:0x4
    v_mov_b32_dpp v92, v105 row_ror:12 row_mask:0xf bank_mask:0x8
    v_mov_b32_dpp v93, v105 row_ror:8 row_mask:0xf bank_mask:0x8
    v_mov_b32_dpp v94, v105 row_ror:4 row_mask:0xf bank_mask:0x8
    v_mov_b32_dpp v95, v105 quad_perm:[0,1,2,3] row_mask:0xf bank_mask:0x8
    s_lshl_b32 s7, s3, 11
    s_add_u32 s7, s7, 115968
    v_add_u32 v12, s7, v8
    v_add_u32 v13, 1024, v12
    s_lshl_b32 s7, s3, 9
    s_add_u32 s7, s7, 115968
    v_and_b32 v106, 3, v1
    v_lshrrev_b32 v107, 2, v1
    v_lshlrev_b32 v104, 3, v107
    v_lshl_add_u32 v104, v106, 7, v104
    v_add_u32 v104, s7, v104
    s_lshl_b32 s7, s3, 5
    s_add_u32 s7, s7, 115840
    v_mov_b32 v105, s7
    v_and_b32 v9, 7, v107
    v_lshlrev_b32 v9, 8, v9
    v_lshl_add_u32 v9, v106, 2, v9
    v_lshrrev_b32 v107, 5, v1
    v_lshl_add_u32 v9, v107, 12, v9
    s_waitcnt vmcnt(6)
    v_perm_b32 v16, v52, v48, s59
    v_perm_b32 v20, v52, v48, s60
    v_perm_b32 v24, v53, v49, s59
    v_perm_b32 v28, v53, v49, s60
    v_perm_b32 v32, v54, v50, s59
    v_perm_b32 v36, v54, v50, s60
    v_perm_b32 v40, v55, v51, s59
    v_perm_b32 v44, v55, v51, s60
    s_waitcnt vmcnt(4)
    v_perm_b32 v17, v60, v56, s59
    v_perm_b32 v21, v60, v56, s60
    v_perm_b32 v25, v61, v57, s59
    v_perm_b32 v29, v61, v57, s60
    v_perm_b32 v33, v62, v58, s59
    v_perm_b32 v37, v62, v58, s60
    v_perm_b32 v41, v63, v59, s59
    v_perm_b32 v45, v63, v59, s60
    s_waitcnt vmcnt(2)
    v_perm_b32 v18, v68, v64, s59
    v_perm_b32 v22, v68, v64, s60
    v_perm_b32 v26, v69, v65, s59
    v_perm_b32 v30, v69, v65, s60
    v_perm_b32 v34, v70, v66, s59
    v_perm_b32 v38, v70, v66, s60
    v_perm_b32 v42, v71, v67, s59
    v_perm_b32 v46, v71, v67, s60
    s_waitcnt vmcnt(0)
    v_perm_b32 v19, v76, v72, s59
    v_perm_b32 v23, v76, v72, s60
    v_perm_b32 v27, v77, v73, s59
    v_perm_b32 v31, v77, v73, s60
    v_perm_b32 v35, v78, v74, s59
    v_perm_b32 v39, v78, v74, s60
    v_perm_b32 v43, v79, v75, s59
    v_perm_b32 v47, v79, v75, s60
    v_mfma_f32_16x16x32_bf16 v[96:99], v[80:83], v[16:19], 0
    v_mfma_f32_16x16x32_bf16 v[100:103], v[80:83], v[20:23], 0
    v_mfma_f32_16x16x32_bf16 v[96:99], v[84:87], v[24:27], v[96:99]
    v_mfma_f32_16x16x32_bf16 v[100:103], v[84:87], v[28:31], v[100:103]
    v_mfma_f32_16x16x32_bf16 v[96:99], v[88:91], v[32:35], v[96:99]
    v_mfma_f32_16x16x32_bf16 v[100:103], v[88:91], v[36:39], v[100:103]
    v_mfma_f32_16x16x32_bf16 v[96:99], v[92:95], v[40:43], v[96:99]
    v_mfma_f32_16x16x32_bf16 v[100:103], v[92:95], v[44:47], v[100:103]
    s_mov_b64 exec, s[0:1]
    s_lshl_b32 s7, s3, 12
    s_add_u32 m0, s7, 65536
    s_mov_b32 s7, s63
    buffer_load_dwordx4 v113, s[44:47], s7 offen nt lds
    s_add_u32 m0, m0, 1024
    s_add_u32 s7, s7, 8192
    buffer_load_dwordx4 v114, s[44:47], s7 offen nt lds
    s_add_u32 m0, m0, 1024
    s_add_u32 s7, s7, 8192
    buffer_load_dwordx4 v113, s[44:47], s7 offen nt lds
    s_add_u32 m0, m0, 1024
    s_add_u32 s7, s7, 8192
    buffer_load_dwordx4 v114, s[44:47], s7 offen nt lds
    s_mov_b64 exec, -1
    ds_write2_b32 v12, v96, v100 offset0:0 offset1:1
    ds_write2_b32 v12, v97, v101 offset0:128 offset1:129
    ds_write2_b32 v13, v98, v102 offset0:0 offset1:1
    ds_write2_b32 v13, v99, v103 offset0:128 offset1:129
    s_waitcnt lgkmcnt(0)
    s_barrier
    s_cmp_ge_u32 s3, 4
    s_cbranch_scc1 L_pub_doneG
    ds_read_b128 v[96:99], v105
    ds_read_b128 v[100:103], v105 offset:16
    ds_read_b64 v[16:17], v104 offset:0
    ds_read_b64 v[18:19], v104 offset:2048
    ds_read_b64 v[20:21], v104 offset:4096
    ds_read_b64 v[22:23], v104 offset:6144
    ds_read_b64 v[24:25], v104 offset:8192
    ds_read_b64 v[26:27], v104 offset:10240
    ds_read_b64 v[28:29], v104 offset:12288
    ds_read_b64 v[30:31], v104 offset:14336
    s_waitcnt lgkmcnt(8)
    v_pk_add_f32 v[96:97], v[96:97], v[98:99]
    v_pk_add_f32 v[100:101], v[100:101], v[102:103]
    v_pk_add_f32 v[96:97], v[96:97], v[100:101]
    v_add_f32 v96, v96, v97
    v_rcp_f32 v97, v96
    v_log_f32 v98, v96
    s_waitcnt lgkmcnt(0)
    v_pk_add_f32 v[16:17], v[16:17], v[18:19]
    v_pk_add_f32 v[20:21], v[20:21], v[22:23]
    v_pk_add_f32 v[24:25], v[24:25], v[26:27]
    v_pk_add_f32 v[28:29], v[28:29], v[30:31]
    v_pk_add_f32 v[16:17], v[16:17], v[20:21]
    v_pk_add_f32 v[24:25], v[24:25], v[28:29]
    v_pk_add_f32 v[16:17], v[16:17], v[24:25]
    v_mul_f32 v16, v16, v97
    v_mul_f32 v17, v17, v97
    v_cvt_pk_bf16_f32 v16, v16, v17
    v_mov_b32 v99, s101
    v_fmac_f32 v98, s58, v99
    v_min_u32 v16, -2, v16
    v_min_u32 v98, -2, v98
    buffer_store_dword v16, v9, s[40:43], s98 offen
    s_mov_b64 exec, 1
    buffer_store_dword v98, off, s[40:43], s99
    s_mov_b64 exec, -1
    s_cmp_eq_u32 s97, 0
    s_cbranch_scc1 L_pub_doneG
    s_lshl_b32 s7, s5, 10
    s_add_u32 s7, s7, s6
    s_lshl_b32 s49, s3, 8
    s_add_u32 s7, s7, s49
    s_add_u32 s7, s7, 65536
    s_add_u32 s49, s99, 65536
    v_lshlrev_b32 v4, 2, v1
    buffer_store_dword v98, off, s[40:43], s49 sc1
    buffer_store_dword v16, v4, s[40:43], s7 offen sc1
L_pub_doneG:
    s_barrier
    s_mov_b32 m0, s54
    s_nop 0
    buffer_load_dwordx4 v6, s[28:31], s51 offen  lds
    s_add_u32 m0, s54, 1024
    s_add_u32 s7, s51, 14336
    buffer_load_dwordx4 v6, s[28:31], s7 offen  lds
    s_mov_b32 m0, s55
    s_nop 0
    buffer_load_dwordx4 v6, s[28:31], s52 offen nt lds
    s_add_u32 m0, s55, 1024
    s_add_u32 s7, s52, 14336
    buffer_load_dwordx4 v6, s[28:31], s7 offen nt lds
    s_xor_b32 s54, s54, 4096
    s_xor_b32 s55, s55, 4096
    s_mov_b32 m0, s54
    s_nop 0
    buffer_load_dwordx4 v6, s[32:35], s51 offen  lds
    s_add_u32 m0, s54, 1024
    s_add_u32 s7, s51, 14336
    buffer_load_dwordx4 v6, s[32:35], s7 offen  lds
    s_mov_b32 m0, s55
    s_nop 0
    buffer_load_dwordx4 v6, s[32:35], s52 offen nt lds
    s_add_u32 m0, s55, 1024
    s_add_u32 s7, s52, 14336
    buffer_load_dwordx4 v6, s[32:35], s7 offen nt lds
    s_lshl_b32 s54, s3, 12
    s_add_u32 s54, s54, 65536
    s_not_b64 exec, s[0:1]
    s_lshl_b32 s7, s3, 12
    s_add_u32 m0, s7, 65536
    s_mov_b32 s7, s63
    buffer_load_dwordx4 v113, s[44:47], s7 offen nt lds
    s_add_u32 m0, m0, 1024
    s_add_u32 s7, s7, 8192
    buffer_load_dwordx4 v114, s[44:47], s7 offen nt lds
    s_add_u32 m0, m0, 1024
    s_add_u32 s7, s7, 8192
    buffer_load_dwordx4 v113, s[44:47], s7 offen nt lds
    s_add_u32 m0, m0, 1024
    s_add_u32 s7, s7, 8192
    buffer_load_dwordx4 v114, s[44:47], s7 offen nt lds
    s_mov_b64 exec, -1
    v_bfe_u32 v116, v1, 2, 2
    v_and_b32 v117, 3, v1
    v_lshlrev_b32 v118, 10, v11
    v_lshl_add_u32 v118, v116, 7, v118
    v_lshl_add_u32 v118, v117, 3, v118
    v_lshrrev_b32 v119, 1, v116
    v_lshl_add_u32 v118, v119, 5, v118
    v_and_b32 v119, 1, v11
    v_lshl_add_u32 v118, v119, 6, v118
    v_add_u32 v118, s54, v118
    v_xor_b32 v119, 32, v118
    v_xor_b32 v120, 64, v118
    v_xor_b32 v121, 64, v119
    v_lshlrev_b32 v122, 4, v11
    v_lshl_add_u32 v122, v117, 6, v122
    v_add_u32 v122, 142592, v122
    v_lshlrev_b32 v123, 8, v116
    v_lshl_add_u32 v123, v11, 6, v123
    v_lshl_add_u32 v123, v117, 4, v123
    v_mov_b32 v124, 0xff
    s_lshl_b32 s7, s62, 1
    s_add_u32 s7, s7, s50
    s_lshl_b32 s7, s7, 3
    s_add_u32 s7, s7, s3
    s_lshl_b32 s63, s7, 10
    s_add_u32 s63, s63, 3145728
    s_add_u32 s100, s100, 1
    s_lshl_b32 s7, s3, 13
    v_add_u32 v14, s7, v14
    v_xor_b32 v9, 32, v14
    v_and_b32 v12, 3, v10
    v_lshlrev_b32 v13, 10, v12
    v_lshl_add_u32 v13, v11, 4, v13
    v_lshlrev_b32 v12, 4, v12
    v_lshl_add_u32 v12, v11, 6, v12
    s_lshl_b32 s48, s50, 12
    s_add_u32 s48, s48, s6
    s_add_u32 s48, s48, 32768
    s_lshl_b32 s7, s3, 7
    s_add_u32 s49, s48, s7
    s_add_u32 s49, s49, 65536
    s_lshl_b32 s7, s3, 9
    s_add_u32 s48, s48, s7
    s_waitcnt vmcnt(0)
    ds_read_b64_tr_b16 v[48:49], v14 offset:0
    ds_read_b64_tr_b16 v[50:51], v14 offset:1024
    ds_read_b64_tr_b16 v[52:53], v14 offset:2048
    ds_read_b64_tr_b16 v[54:55], v14 offset:3072
    ds_read_b64_tr_b16 v[56:57], v14 offset:4096
    ds_read_b64_tr_b16 v[58:59], v14 offset:5120
    ds_read_b64_tr_b16 v[60:61], v14 offset:6144
    ds_read_b64_tr_b16 v[62:63], v14 offset:7168
    ds_read_b64_tr_b16 v[64:65], v9 offset:0
    ds_read_b64_tr_b16 v[66:67], v9 offset:1024
    ds_read_b64_tr_b16 v[68:69], v9 offset:2048
    ds_read_b64_tr_b16 v[70:71], v9 offset:3072
    ds_read_b64_tr_b16 v[72:73], v9 offset:4096
    ds_read_b64_tr_b16 v[74:75], v9 offset:5120
    ds_read_b64_tr_b16 v[76:77], v9 offset:6144
    ds_read_b64_tr_b16 v[78:79], v9 offset:7168
    ds_read_b64_tr_b16 v[80:81], v118 offset:0
    ds_read_b64_tr_b16 v[82:83], v118 offset:512
    ds_read_b64_tr_b16 v[84:85], v119 offset:0
    ds_read_b64_tr_b16 v[86:87], v119 offset:512
    ds_read_b64_tr_b16 v[88:89], v120 offset:0
    ds_read_b64_tr_b16 v[90:91], v120 offset:512
    ds_read_b64_tr_b16 v[92:93], v121 offset:0
    ds_read_b64_tr_b16 v[94:95], v121 offset:512
    s_cmp_eq_u32 s97, 0
    s_cselect_b32 s49, s48, s49
    s_cselect_b32 s7, 256, 64
    s_cselect_b64 vcc, -1, 0
    v_cndmask_b32 v12, v13, v12, vcc
    s_add_u32 s48, s49, s7
L_g_re:
    buffer_load_dwordx4 v[16:19], v12, s[40:43], s49 offen sc1
    buffer_load_dwordx4 v[20:23], v12, s[40:43], s48 offen sc1
L_g_poll:
    s_sub_u32 s96, s96, 1
    s_cbranch_scc1 L_end
    buffer_load_dwordx4 v[16:19], v12, s[40:43], s49 offen sc1
    buffer_load_dwordx4 v[20:23], v12, s[40:43], s48 offen sc1
    s_waitcnt vmcnt(2)
    v_max3_u32 v24, v16, v17, v18
    v_max3_u32 v24, v24, v19, v20
    v_max3_u32 v24, v24, v21, v22
    v_max_u32 v24, v24, v23
    v_cmp_eq_u32 vcc, -1, v24
    s_cmp_eq_u32 s97, 0
    s_cbranch_vccnz L_g_poll
    s_cbranch_scc0 L_g_sl
L_g_ok:
    s_waitcnt lgkmcnt(0)
    v_mfma_f32_16x16x32_bf16 v[96:99], v[48:51], v[16:19], 0
    v_mfma_f32_16x16x32_bf16 v[100:103], v[56:59], v[16:19], 0
    v_mfma_f32_16x16x32_bf16 v[104:107], v[64:67], v[16:19], 0
    v_mfma_f32_16x16x32_bf16 v[108:111], v[72:75], v[16:19], 0
    v_mfma_f32_16x16x32_bf16 v[96:99], v[52:55], v[20:23], v[96:99]
    v_mfma_f32_16x16x32_bf16 v[100:103], v[60:63], v[20:23], v[100:103]
    v_mfma_f32_16x16x32_bf16 v[104:107], v[68:71], v[20:23], v[104:107]
    v_mfma_f32_16x16x32_bf16 v[108:111], v[76:79], v[20:23], v[108:111]
    s_nop 5
    v_mov_b32_dpp v96, v100 quad_perm:[0,1,2,3] row_mask:0xf bank_mask:0x2
    v_mov_b32_dpp v97, v101 quad_perm:[0,1,2,3] row_mask:0xf bank_mask:0x2
    v_mov_b32_dpp v98, v102 quad_perm:[0,1,2,3] row_mask:0xf bank_mask:0x2
    v_mov_b32_dpp v99, v103 quad_perm:[0,1,2,3] row_mask:0xf bank_mask:0x2
    v_mov_b32_dpp v96, v104 quad_perm:[0,1,2,3] row_mask:0xf bank_mask:0x4
    v_mov_b32_dpp v97, v105 quad_perm:[0,1,2,3] row_mask:0xf bank_mask:0x4
    v_mov_b32_dpp v98, v106 quad_perm:[0,1,2,3] row_mask:0xf bank_mask:0x4
    v_mov_b32_dpp v99, v107 quad_perm:[0,1,2,3] row_mask:0xf bank_mask:0x4
    v_mov_b32_dpp v96, v108 quad_perm:[0,1,2,3] row_mask:0xf bank_mask:0x8
    v_mov_b32_dpp v97, v109 quad_perm:[0,1,2,3] row_mask:0xf bank_mask:0x8
    v_mov_b32_dpp v98, v110 quad_perm:[0,1,2,3] row_mask:0xf bank_mask:0x8
    v_mov_b32_dpp v99, v111 quad_perm:[0,1,2,3] row_mask:0xf bank_mask:0x8
    ds_write_b128 v15, v[96:99]
    s_waitcnt lgkmcnt(0)
    s_barrier
    s_barrier
    ds_read_b128 v[28:31], v122
    s_waitcnt lgkmcnt(0)
    v_mfma_f32_16x16x32_bf16 v[96:99], v[80:83], v[28:31], 0
    v_mfma_f32_16x16x32_bf16 v[100:103], v[84:87], v[28:31], 0
    v_mfma_f32_16x16x32_bf16 v[104:107], v[88:91], v[28:31], 0
    v_mfma_f32_16x16x32_bf16 v[108:111], v[92:95], v[28:31], 0
    s_nop 5
    v_mov_b32_dpp v96, v100 quad_perm:[0,1,2,3] row_mask:0xf bank_mask:0x2
    v_mov_b32_dpp v97, v101 quad_perm:[0,1,2,3] row_mask:0xf bank_mask:0x2
    v_mov_b32_dpp v98, v102 quad_perm:[0,1,2,3] row_mask:0xf bank_mask:0x2
    v_mov_b32_dpp v99, v103 quad_perm:[0,1,2,3] row_mask:0xf bank_mask:0x2
    v_mov_b32_dpp v96, v104 quad_perm:[0,1,2,3] row_mask:0xf bank_mask:0x4
    v_mov_b32_dpp v97, v105 quad_perm:[0,1,2,3] row_mask:0xf bank_mask:0x4
    v_mov_b32_dpp v98, v106 quad_perm:[0,1,2,3] row_mask:0xf bank_mask:0x4
    v_mov_b32_dpp v99, v107 quad_perm:[0,1,2,3] row_mask:0xf bank_mask:0x4
    v_mov_b32_dpp v96, v108 quad_perm:[0,1,2,3] row_mask:0xf bank_mask:0x8
    v_mov_b32_dpp v97, v109 quad_perm:[0,1,2,3] row_mask:0xf bank_mask:0x8
    v_mov_b32_dpp v98, v110 quad_perm:[0,1,2,3] row_mask:0xf bank_mask:0x8
    v_mov_b32_dpp v99, v111 quad_perm:[0,1,2,3] row_mask:0xf bank_mask:0x8
    v_bfi_b32 v96, v124, s100, v96
    v_bfi_b32 v97, v124, s100, v97
    v_bfi_b32 v98, v124, s100, v98
    v_bfi_b32 v99, v124, s100, v99
    buffer_store_dwordx4 v[96:99], v123, s[40:43], s63 offen sc1
    s_branch L_kv_end
L_g_sl:
    s_waitcnt vmcnt(0)
    v_max3_u32 v24, v16, v17, v18
    v_max3_u32 v24, v24, v19, v20
    v_max3_u32 v24, v24, v21, v22
    v_max_u32 v24, v24, v23
    v_cmp_eq_u32 vcc, -1, v24
    s_cbranch_vccnz L_g_re
    s_branch L_g_ok
L_D:
    s_barrier
    ds_read_b128 v[104:107], v13
    v_mov_b32 v110, 143744
    ds_read_b32 v108, v110
    s_waitcnt vmcnt(8) lgkmcnt(0)
    v_mfma_f32_16x16x32_bf16 v[96:99], v[16:19], v[104:107], 0
    v_mfma_f32_16x16x32_bf16 v[16:19], v[20:23], v[104:107], 0
    v_mfma_f32_16x16x32_bf16 v[20:23], v[24:27], v[104:107], 0
    v_mfma_f32_16x16x32_bf16 v[24:27], v[28:31], v[104:107], 0
    v_mfma_f32_16x16x32_bf16 v[28:31], v[32:35], v[104:107], 0
    v_mfma_f32_16x16x32_bf16 v[32:35], v[36:39], v[104:107], 0
    v_mfma_f32_16x16x32_bf16 v[36:39], v[40:43], v[104:107], 0
    v_mfma_f32_16x16x32_bf16 v[40:43], v[44:47], v[104:107], 0
    s_nop 0
    v_add_f32_dpp v96, v97, v96 row_ror:12 row_mask:0xf bank_mask:0xf
    v_add_f32_dpp v17, v18, v17 row_ror:12 row_mask:0xf bank_mask:0xf
    v_add_f32_dpp v22, v23, v22 row_ror:12 row_mask:0xf bank_mask:0xf
    v_add_f32_dpp v27, v24, v27 row_ror:12 row_mask:0xf bank_mask:0xf
    v_add_f32_dpp v28, v29, v28 row_ror:12 row_mask:0xf bank_mask:0xf
    v_add_f32_dpp v33, v34, v33 row_ror:12 row_mask:0xf bank_mask:0xf
    v_add_f32_dpp v38, v39, v38 row_ror:12 row_mask:0xf bank_mask:0xf
    v_add_f32_dpp v43, v40, v43 row_ror:12 row_mask:0xf bank_mask:0xf
    v_readfirstlane_b32 s97, v108
    v_add_f32_dpp v96, v98, v96 row_ror:8 row_mask:0xf bank_mask:0xf
    v_add_f32_dpp v28, v30, v28 row_ror:8 row_mask:0xf bank_mask:0xf
    v_add_f32_dpp v17, v19, v17 row_ror:8 row_mask:0xf bank_mask:0xf
    v_add_f32_dpp v33, v35, v33 row_ror:8 row_mask:0xf bank_mask:0xf
    v_add_f32_dpp v100, v99, v96 row_ror:4 row_mask:0xf bank_mask:0x1
    v_add_f32_dpp v22, v20, v22 row_ror:8 row_mask:0xf bank_mask:0xf
    v_add_f32_dpp v101, v31, v28 row_ror:4 row_mask:0xf bank_mask:0x1
    v_add_f32_dpp v38, v36, v38 row_ror:8 row_mask:0xf bank_mask:0xf
    v_add_f32_dpp v100, v16, v17 row_ror:4 row_mask:0xf bank_mask:0x2
    v_add_f32_dpp v27, v25, v27 row_ror:8 row_mask:0xf bank_mask:0xf
    v_add_f32_dpp v101, v32, v33 row_ror:4 row_mask:0xf bank_mask:0x2
    v_add_f32_dpp v43, v41, v43 row_ror:8 row_mask:0xf bank_mask:0xf
    v_add_f32_dpp v100, v21, v22 row_ror:4 row_mask:0xf bank_mask:0x4
    v_add_f32_dpp v101, v37, v38 row_ror:4 row_mask:0xf bank_mask:0x4
    s_nop 0
    v_add_f32_dpp v100, v26, v27 row_ror:4 row_mask:0xf bank_mask:0x8
    v_add_f32_dpp v101, v42, v43 row_ror:4 row_mask:0xf bank_mask:0x8
    v_cvt_pk_bf16_f32 v102, v100, v101
    v_lshlrev_b32 v100, 16, v102
    v_and_b32 v101, s56, v102
    v_mul_f32 v100, s57, v100
    v_mul_f32 v101, s57, v101
    v_cvt_pk_bf16_f32 v102, v100, v101
    v_lshlrev_b32 v100, 16, v102
    v_and_b32 v101, s56, v102
    v_max_f32 v102, v100, v101
    s_nop 1
    v_max_f32_dpp v102, v102, v102 row_ror:4 row_mask:0xf bank_mask:0xf
    s_nop 1
    v_max_f32_dpp v102, v102, v102 row_ror:8 row_mask:0xf bank_mask:0xf
    v_mov_b32 v103, v102
    s_nop 1
    v_permlane16_swap_b32 v102, v103
    v_max_f32 v102, v102, v103
    v_mov_b32 v103, v102
    s_nop 1
    v_permlane32_swap_b32 v102, v103
    v_max_f32 v102, v102, v103
    ds_write_b32 v9, v102
    s_waitcnt lgkmcnt(0)
    s_barrier
    ds_read_b128 v[104:107], v12
    ds_read_b128 v[108:111], v12 offset:16
    s_waitcnt lgkmcnt(0)
    v_max3_f32 v102, v104, v105, v106
    v_max3_f32 v103, v107, v108, v109
    v_max3_f32 v102, v102, v110, v111
    v_max_f32 v104, v102, v103
    v_sub_f32 v100, v100, v104
    v_sub_f32 v101, v101, v104
    v_mul_f32 v100, s58, v100
    v_mul_f32 v101, s58, v101
    v_exp_f32 v100, v100
    v_exp_f32 v101, v101
    v_readlane_b32 s101, v104, s3
    v_cvt_pk_bf16_f32 v105, v100, v101
    v_add_f32 v102, v100, v101
    s_nop 1
    v_add_f32_dpp v102, v102, v102 row_ror:4 row_mask:0xf bank_mask:0xf
    s_nop 1
    v_add_f32_dpp v102, v102, v102 row_ror:8 row_mask:0xf bank_mask:0xf
    v_mov_b32 v103, v102
    s_nop 1
    v_permlane16_swap_b32 v102, v103
    v_add_f32 v102, v102, v103
    v_mov_b32 v103, v102
    s_nop 1
    v_permlane32_swap_b32 v102, v103
    v_add_f32 v102, v102, v103
    ds_write_b32 v9, v102 offset:128
    v_mov_b32_dpp v80, v105 quad_perm:[0,1,2,3] row_mask:0xf bank_mask:0x1
    v_mov_b32_dpp v81, v105 row_ror:12 row_mask:0xf bank_mask:0x1
    v_mov_b32_dpp v82, v105 row_ror:8 row_mask:0xf bank_mask:0x1
    v_mov_b32_dpp v83, v105 row_ror:4 row_mask:0xf bank_mask:0x1
    v_mov_b32_dpp v84, v105 row_ror:4 row_mask:0xf bank_mask:0x2
    v_mov_b32_dpp v85, v105 quad_perm:[0,1,2,3] row_mask:0xf bank_mask:0x2
    v_mov_b32_dpp v86, v105 row_ror:12 row_mask:0xf bank_mask:0x2
    v_mov_b32_dpp v87, v105 row_ror:8 row_mask:0xf bank_mask:0x2
    v_mov_b32_dpp v88, v105 row_ror:8 row_mask:0xf bank_mask:0x4
    v_mov_b32_dpp v89, v105 row_ror:4 row_mask:0xf bank_mask:0x4
    v_mov_b32_dpp v90, v105 quad_perm:[0,1,2,3] row_mask:0xf bank_mask:0x4
    v_mov_b32_dpp v91, v105 row_ror:12 row_mask:0xf bank_mask:0x4
    v_mov_b32_dpp v92, v105 row_ror:12 row_mask:0xf bank_mask:0x8
    v_mov_b32_dpp v93, v105 row_ror:8 row_mask:0xf bank_mask:0x8
    v_mov_b32_dpp v94, v105 row_ror:4 row_mask:0xf bank_mask:0x8
    v_mov_b32_dpp v95, v105 quad_perm:[0,1,2,3] row_mask:0xf bank_mask:0x8
    s_lshl_b32 s7, s3, 11
    s_add_u32 s7, s7, 115968
    v_add_u32 v12, s7, v8
    v_add_u32 v13, 1024, v12
    s_lshl_b32 s7, s3, 9
    s_add_u32 s7, s7, 115968
    v_and_b32 v106, 3, v1
    v_lshrrev_b32 v107, 2, v1
    v_lshlrev_b32 v104, 3, v107
    v_lshl_add_u32 v104, v106, 7, v104
    v_add_u32 v104, s7, v104
    s_lshl_b32 s7, s3, 5
    s_add_u32 s7, s7, 115840
    v_mov_b32 v105, s7
    v_and_b32 v9, 7, v107
    v_lshlrev_b32 v9, 8, v9
    v_lshl_add_u32 v9, v106, 2, v9
    v_lshrrev_b32 v107, 5, v1
    v_lshl_add_u32 v9, v107, 12, v9
    s_waitcnt vmcnt(6)
    v_perm_b32 v16, v52, v48, s59
    v_perm_b32 v20, v52, v48, s60
    v_perm_b32 v24, v53, v49, s59
    v_perm_b32 v28, v53, v49, s60
    v_perm_b32 v32, v54, v50, s59
    v_perm_b32 v36, v54, v50, s60
    v_perm_b32 v40, v55, v51, s59
    v_perm_b32 v44, v55, v51, s60
    s_waitcnt vmcnt(4)
    v_perm_b32 v17, v60, v56, s59
    v_perm_b32 v21, v60, v56, s60
    v_perm_b32 v25, v61, v57, s59
    v_perm_b32 v29, v61, v57, s60
    v_perm_b32 v33, v62, v58, s59
    v_perm_b32 v37, v62, v58, s60
    v_perm_b32 v41, v63, v59, s59
    v_perm_b32 v45, v63, v59, s60
    s_waitcnt vmcnt(2)
    v_perm_b32 v18, v68, v64, s59
    v_perm_b32 v22, v68, v64, s60
    v_perm_b32 v26, v69, v65, s59
    v_perm_b32 v30, v69, v65, s60
    v_perm_b32 v34, v70, v66, s59
    v_perm_b32 v38, v70, v66, s60
    v_perm_b32 v42, v71, v67, s59
    v_perm_b32 v46, v71, v67, s60
    s_waitcnt vmcnt(0)
    v_perm_b32 v19, v76, v72, s59
    v_perm_b32 v23, v76, v72, s60
    v_perm_b32 v27, v77, v73, s59
    v_perm_b32 v31, v77, v73, s60
    v_perm_b32 v35, v78, v74, s59
    v_perm_b32 v39, v78, v74, s60
    v_perm_b32 v43, v79, v75, s59
    v_perm_b32 v47, v79, v75, s60
    v_mfma_f32_16x16x32_bf16 v[96:99], v[80:83], v[16:19], 0
    v_mfma_f32_16x16x32_bf16 v[100:103], v[80:83], v[20:23], 0
    v_mfma_f32_16x16x32_bf16 v[96:99], v[84:87], v[24:27], v[96:99]
    v_mfma_f32_16x16x32_bf16 v[100:103], v[84:87], v[28:31], v[100:103]
    v_mfma_f32_16x16x32_bf16 v[96:99], v[88:91], v[32:35], v[96:99]
    v_mfma_f32_16x16x32_bf16 v[100:103], v[88:91], v[36:39], v[100:103]
    v_mfma_f32_16x16x32_bf16 v[96:99], v[92:95], v[40:43], v[96:99]
    v_mfma_f32_16x16x32_bf16 v[100:103], v[92:95], v[44:47], v[100:103]
    s_nop 7
    ds_write2_b32 v12, v96, v100 offset0:0 offset1:1
    ds_write2_b32 v12, v97, v101 offset0:128 offset1:129
    ds_write2_b32 v13, v98, v102 offset0:0 offset1:1
    ds_write2_b32 v13, v99, v103 offset0:128 offset1:129
    s_waitcnt lgkmcnt(0)
    s_barrier
    s_cmp_ge_u32 s3, 4
    s_cbranch_scc1 L_pub_doneD
    ds_read_b128 v[96:99], v105
    ds_read_b128 v[100:103], v105 offset:16
    ds_read_b64 v[16:17], v104 offset:0
    ds_read_b64 v[18:19], v104 offset:2048
    ds_read_b64 v[20:21], v104 offset:4096
    ds_read_b64 v[22:23], v104 offset:6144
    ds_read_b64 v[24:25], v104 offset:8192
    ds_read_b64 v[26:27], v104 offset:10240
    ds_read_b64 v[28:29], v104 offset:12288
    ds_read_b64 v[30:31], v104 offset:14336
    s_waitcnt lgkmcnt(8)
    v_pk_add_f32 v[96:97], v[96:97], v[98:99]
    v_pk_add_f32 v[100:101], v[100:101], v[102:103]
    v_pk_add_f32 v[96:97], v[96:97], v[100:101]
    v_add_f32 v96, v96, v97
    v_rcp_f32 v97, v96
    v_log_f32 v98, v96
    s_waitcnt lgkmcnt(0)
    v_pk_add_f32 v[16:17], v[16:17], v[18:19]
    v_pk_add_f32 v[20:21], v[20:21], v[22:23]
    v_pk_add_f32 v[24:25], v[24:25], v[26:27]
    v_pk_add_f32 v[28:29], v[28:29], v[30:31]
    v_pk_add_f32 v[16:17], v[16:17], v[20:21]
    v_pk_add_f32 v[24:25], v[24:25], v[28:29]
    v_pk_add_f32 v[16:17], v[16:17], v[24:25]
    v_mul_f32 v16, v16, v97
    v_mul_f32 v17, v17, v97
    v_cvt_pk_bf16_f32 v16, v16, v17
    v_mov_b32 v99, s101
    v_fmac_f32 v98, s58, v99
    v_min_u32 v16, -2, v16
    v_min_u32 v98, -2, v98
    buffer_store_dword v16, v9, s[40:43], s98 offen
    s_mov_b64 exec, 1
    buffer_store_dword v98, off, s[40:43], s99
    s_mov_b64 exec, -1
    s_cmp_eq_u32 s97, 0
    s_cbranch_scc1 L_pub_doneD
    s_lshl_b32 s7, s5, 10
    s_add_u32 s7, s7, s6
    s_lshl_b32 s49, s3, 8
    s_add_u32 s7, s7, s49
    s_add_u32 s7, s7, 65536
    s_add_u32 s49, s99, 65536
    v_lshlrev_b32 v4, 2, v1
    buffer_store_dword v98, off, s[40:43], s49 sc1
    buffer_store_dword v16, v4, s[40:43], s7 offen sc1
L_pub_doneD:
    s_barrier
L_kv_end:
    s_endpgm
L_aux:
    s_setprio 3
    s_mov_b32 s42, 0x10000000
    s_mov_b32 s43, 0x20000
    s_mov_b32 s26, 0x400000
    s_mov_b32 s27, 0x20000
    s_mov_b32 s30, 0x1c0000
    s_mov_b32 s31, 0x20000
    s_mov_b32 s34, 0x1c0000
    s_mov_b32 s35, 0x20000
    s_mov_b32 s38, 0x2000
    s_mov_b32 s39, 0x20000
    v_lshrrev_b32 v11, 4, v1
    v_and_b32 v12, 3, v1
    v_bfe_u32 v9, v1, 2, 2
    s_lshl_b32 s6, s4, 17
    s_add_u32 s6, s6, 262144
    s_mov_b32 s56, 0xffff0000
    s_mov_b32 s96, 300000
    v_lshlrev_b32 v8, 3, v1
    v_and_b32 v10, 15, v1
    v_and_b32 v13, 1, v11
    v_mov_b32 v100, -1
    v_mov_b32 v101, -1
    v_mov_b32 v102, -1
    v_mov_b32 v103, -1
    s_lshl_b32 s58, s5, 1
    s_add_u32 s58, s58, s3
    s_lshl_b32 s7, s58, 10
    s_add_u32 s59, s7, s6
    s_getreg_b32 s63, hwreg(HW_REG_XCC_ID, 0, 4)
    s_waitcnt lgkmcnt(0)
    s_mov_b64 s[40:41], s[90:91]
    s_mov_b64 s[16:17], s[72:73]
    s_mov_b64 s[24:25], s[76:77]
    s_mov_b64 s[28:29], s[80:81]
    s_mov_b64 s[32:33], s[82:83]
    s_mov_b64 s[44:45], s[84:85]
    s_mov_b64 s[36:37], s[86:87]
    s_load_dword s48, s[40:41], 0
    s_cmp_ge_u32 s58, 43
    s_cbranch_scc1 L_a_c3
    buffer_store_dwordx4 v[100:103], v7, s[40:43], s59 offen
L_a_c3:
    v_lshlrev_b32 v14, 10, v11
    v_lshl_add_u32 v14, v9, 7, v14
    v_lshl_add_u32 v14, v12, 3, v14
    v_lshrrev_b32 v4, 1, v9
    v_lshl_add_u32 v14, v4, 5, v14
    v_lshl_add_u32 v14, v13, 6, v14
    s_lshl_b32 s7, s3, 6
    v_xor_b32 v14, s7, v14
    v_xor_b32 v15, 32, v14
    v_lshrrev_b32 v4, 3, v10
    v_lshl_add_u32 v4, v4, 2, v12
    v_mul_u32_u24 v4, 1040, v4
    v_lshl_add_u32 v4, v11, 4, v4
    s_lshr_b32 s57, s5, 3
    s_and_b32 s57, s57, 2
    s_bitcmp1_b32 s5, 0
    s_addc_u32 s57, s57, 0
    s_lshl_b32 s7, s57, 8
    s_add_u32 s7, s7, 115968
    v_add_u32 v4, s7, v4
    v_and_b32 v5, 31, v1
    v_lshrrev_b32 v6, 5, v1
    v_lshlrev_b32 v2, 2, v5
    v_lshl_add_u32 v2, v6, 15, v2
    s_lshl_b32 s55, s4, 16
    s_add_u32 s55, s55, 2097152
    s_lshl_b32 s51, s57, 11
    s_bfe_u32 s7, s5, 0x30001
    s_xor_b32 s7, s7, 4
    s_lshl_b32 s7, s7, 8
    s_add_u32 s51, s51, s7
    s_lshl_b32 s7, s3, 7
    s_add_u32 s51, s51, s7
    s_add_u32 s51, s51, s55
    s_add_u32 s52, s51, 8192
    s_add_u32 s53, s51, 16384
    s_add_u32 s54, s51, 24576
    v_add_u32 v3, 524288, v2
    v_mov_b32 v104, 0xff
    s_lshr_b32 s7, s5, 2
    s_lshl_b32 s60, s7, 13
    s_add_u32 s60, s60, s55
    s_lshl_b32 s7, s3, 7
    s_add_u32 s60, s60, s7
    s_add_u32 s61, s60, 524288
    s_add_u32 s62, s60, 4096
    s_mov_b32 s49, s60
    v_lshrrev_b32 v106, 3, v1
    v_and_b32 v5, 7, v1
    v_and_b32 v13, 1, v106
    v_lshlrev_b32 v106, 8, v106
    v_lshl_add_u32 v106, v5, 4, v106
    v_lshlrev_b32 v13, 9, v13
    v_lshrrev_b32 v5, 1, v5
    v_lshl_add_u32 v13, v5, 6, v13
    v_lshl_add_u32 v13, v11, 4, v13
    v_and_b32 v5, 1, v1
    v_lshl_add_u32 v13, v5, 3, v13
    s_lshl_b32 s7, s3, 8
    s_add_u32 s7, s7, 114688
    v_add_u32 v13, s7, v13
    v_lshlrev_b32 v105, 1, v12
    s_waitcnt lgkmcnt(0)
    s_add_u32 s48, s48, 1
    s_lshl_b32 s63, s63, 4
    s_and_b32 s7, s48, 15
    s_or_b32 s63, s63, s7
    v_lshrrev_b32 v105, v105, s63
    s_bfe_u32 s98, s63, 0x20000
    s_bfe_u32 s99, s63, 0x20002
    s_bfe_u32 s100, s63, 0x20004
    s_bfe_u32 s101, s63, 0x20006
    s_waitcnt vmcnt(0)
    s_barrier
    ds_read_b128 v[16:19], v4 offset:0
    ds_read_b64_tr_b16 v[32:33], v14 offset:0
    ds_read_b64_tr_b16 v[34:35], v14 offset:512
    ds_read_b64_tr_b16 v[36:37], v15 offset:0
    ds_read_b64_tr_b16 v[38:39], v15 offset:512
    ds_read_b128 v[20:23], v4 offset:64
    ds_read_b64_tr_b16 v[40:41], v14 offset:4096
    ds_read_b64_tr_b16 v[42:43], v14 offset:4608
    ds_read_b64_tr_b16 v[44:45], v15 offset:4096
    ds_read_b64_tr_b16 v[46:47], v15 offset:4608
    ds_read_b128 v[24:27], v4 offset:128
    ds_read_b64_tr_b16 v[48:49], v14 offset:8192
    ds_read_b64_tr_b16 v[50:51], v14 offset:8704
    ds_read_b64_tr_b16 v[52:53], v15 offset:8192
    ds_read_b64_tr_b16 v[54:55], v15 offset:8704
    s_waitcnt lgkmcnt(10)
    v_mfma_f32_16x16x32_bf16 v[96:99], v[16:19], v[32:35], 0
    v_mfma_f32_16x16x32_bf16 v[100:103], v[16:19], v[36:39], 0
    ds_read_b128 v[28:31], v4 offset:192
    ds_read_b64_tr_b16 v[56:57], v14 offset:12288
    ds_read_b64_tr_b16 v[58:59], v14 offset:12800
    ds_read_b64_tr_b16 v[60:61], v15 offset:12288
    ds_read_b64_tr_b16 v[62:63], v15 offset:12800
    s_waitcnt lgkmcnt(10)
    v_mfma_f32_16x16x32_bf16 v[96:99], v[20:23], v[40:43], v[96:99]
    v_mfma_f32_16x16x32_bf16 v[100:103], v[20:23], v[44:47], v[100:103]
    s_waitcnt lgkmcnt(5)
    v_mfma_f32_16x16x32_bf16 v[96:99], v[24:27], v[48:51], v[96:99]
    v_mfma_f32_16x16x32_bf16 v[100:103], v[24:27], v[52:55], v[100:103]
    s_waitcnt lgkmcnt(0)
    v_mfma_f32_16x16x32_bf16 v[96:99], v[28:31], v[56:59], v[96:99]
    v_mfma_f32_16x16x32_bf16 v[100:103], v[28:31], v[60:63], v[100:103]
    s_nop 7
    v_mov_b32_dpp v96, v100 quad_perm:[0,1,2,3] row_mask:0xa bank_mask:0xf
    v_mov_b32_dpp v97, v101 quad_perm:[0,1,2,3] row_mask:0xa bank_mask:0xf
    v_mov_b32_dpp v98, v102 quad_perm:[0,1,2,3] row_mask:0xa bank_mask:0xf
    v_mov_b32_dpp v99, v103 quad_perm:[0,1,2,3] row_mask:0xa bank_mask:0xf
    v_bfi_b32 v96, 3, v105, v96
    v_bfi_b32 v97, 3, v105, v97
    v_bfi_b32 v98, 3, v105, v98
    v_bfi_b32 v99, 3, v105, v99
    buffer_store_dword v96, v2, s[40:43], s51 offen
    buffer_store_dword v97, v2, s[40:43], s52 offen
    buffer_store_dword v98, v2, s[40:43], s53 offen
    buffer_store_dword v99, v2, s[40:43], s54 offen
    s_barrier
    v_lshrrev_b32 v9, 3, v1
    v_and_b32 v12, 7, v1
    v_lshrrev_b32 v4, 1, v12
    v_mul_u32_u24 v15, 320, v4
    v_lshl_add_u32 v15, v9, 4, v15
    v_lshl_add_u32 v15, v5, 3, v15
    s_lshl_b32 s7, s3, 7
    s_add_u32 s7, s7, 132352
    v_add_u32 v15, s7, v15
    v_lshlrev_b32 v5, 2, v12
    v_lshl_add_u32 v6, v9, 10, v5
    s_or_b32 s96, s96, 15
    s_barrier
    s_barrier
    buffer_load_dwordx4 v[16:19], v106, s[40:43], s49 offen offset:0 sc1
    buffer_load_dwordx4 v[20:23], v106, s[40:43], s49 offen offset:2048 sc1
    buffer_load_dwordx4 v[24:27], v106, s[40:43], s62 offen offset:0 sc1
    buffer_load_dwordx4 v[28:31], v106, s[40:43], s62 offen offset:2048 sc1
    s_barrier
    s_branch L_q_ld
L_q_poll:
    s_sub_u32 s96, s96, 1
    s_cbranch_scc1 L_end
    s_and_b32 s7, s96, 7
    s_cselect_b32 s49, s60, s61
    s_cbranch_scc1 L_q_ld2
    buffer_store_dword v96, v3, s[40:43], s51 offen sc1
    buffer_store_dword v97, v3, s[40:43], s52 offen sc1
    buffer_store_dword v98, v3, s[40:43], s53 offen sc1
    buffer_store_dword v99, v3, s[40:43], s54 offen sc1
L_q_ld2:
    s_add_u32 s62, s49, 4096
    buffer_load_dwordx4 v[16:19], v106, s[40:43], s49 offen offset:0 sc1
    buffer_load_dwordx4 v[20:23], v106, s[40:43], s49 offen offset:2048 sc1
    buffer_load_dwordx4 v[24:27], v106, s[40:43], s62 offen offset:0 sc1
    buffer_load_dwordx4 v[28:31], v106, s[40:43], s62 offen offset:2048 sc1
L_q_ld:
    s_waitcnt vmcnt(0)
    v_xor_b32 v16, s98, v16
    v_xor_b32 v17, s99, v17
    v_xor_b32 v18, s100, v18
    v_xor_b32 v19, s101, v19
    v_xor_b32 v20, s98, v20
    v_xor_b32 v21, s99, v21
    v_xor_b32 v22, s100, v22
    v_xor_b32 v23, s101, v23
    v_xor_b32 v24, s98, v24
    v_xor_b32 v25, s99, v25
    v_xor_b32 v26, s100, v26
    v_xor_b32 v27, s101, v27
    v_xor_b32 v28, s98, v28
    v_xor_b32 v29, s99, v29
    v_xor_b32 v30, s100, v30
    v_xor_b32 v31, s101, v31
    v_or_b32 v32, v16, v17
    v_or_b32 v33, v18, v19
    v_or3_b32 v32, v32, v20, v21
    v_or3_b32 v33, v33, v22, v23
    v_or3_b32 v32, v32, v24, v25
    v_or3_b32 v33, v33, v26, v27
    v_or3_b32 v32, v32, v28, v29
    v_or3_b32 v33, v33, v30, v31
    v_and_b32 v32, 3, v32
    v_and_b32 v33, 3, v33
    v_cmp_ne_u32 vcc, 0, v32
    v_cmp_ne_u32 s[0:1], 0, v33
    v_and_b32 v18, -4, v18
    v_and_b32 v19, -4, v19
    v_and_b32 v22, -4, v22
    v_and_b32 v23, -4, v23
    v_and_b32 v26, -4, v26
    v_and_b32 v27, -4, v27
    v_and_b32 v30, -4, v30
    v_and_b32 v31, -4, v31
    s_cbranch_vccnz L_q_poll
    v_pk_add_f32 v[16:17], v[16:17], v[20:21]
    v_pk_add_f32 v[18:19], v[18:19], v[22:23]
    v_pk_add_f32 v[24:25], v[24:25], v[28:29]
    v_pk_add_f32 v[26:27], v[26:27], v[30:31]
    v_pk_add_f32 v[16:17], v[16:17], v[24:25]
    v_pk_add_f32 v[18:19], v[18:19], v[26:27]
    s_or_b32 s97, s0, s1
    v_mov_b32 v20, s97
    v_mov_b32 v21, 143744
    v_cvt_pk_bf16_f32 v16, v16, v17
    v_cvt_pk_bf16_f32 v17, v18, v19
    ds_write_b64 v13, v[16:17]
    ds_write_b32 v21, v20
    s_cmp_eq_u32 s97, 0
    s_cbranch_scc1 L_a_fast
    buffer_store_dword v96, v3, s[40:43], s51 offen sc1
    buffer_store_dword v97, v3, s[40:43], s52 offen sc1
    buffer_store_dword v98, v3, s[40:43], s53 offen sc1
    buffer_store_dword v99, v3, s[40:43], s54 offen sc1
    v_mov_b32 v100, -1
    v_mov_b32 v101, -1
    v_mov_b32 v102, -1
    v_mov_b32 v103, -1
    s_cmp_ge_u32 s58, 43
    s_cbranch_scc1 L_a_s1
    s_add_u32 s7, s59, 65536
    buffer_store_dwordx4 v[100:103], v7, s[40:43], s7 offen sc1
L_a_s1:
    s_add_u32 s49, s6, 45056
    s_lshl_b32 s7, s58, 2
    s_add_u32 s7, s7, s49
    v_mov_b32 v20, s48
    v_lshlrev_b32 v21, 2, v1
    s_waitcnt vmcnt(0)
    buffer_store_dword v20, off, s[40:43], s7 sc1
L_a_s2:
    s_sub_u32 s96, s96, 1
    s_cbranch_scc1 L_end
    buffer_load_dword v22, v21, s[40:43], s49 offen sc1
    s_waitcnt vmcnt(0)
    v_cmp_ne_u32 vcc, s48, v22
    s_cbranch_vccnz L_a_s2
L_a_fast:
    s_waitcnt lgkmcnt(0)
    s_barrier
    s_cmp_ge_u32 s58, 43
    s_cbranch_scc1 L_a_nt
    buffer_load_dwordx4 v[100:103], v7, s[40:43], s59 offen sc1
L_a_nt:
    s_lshl_b32 s7, s4, 6
    s_add_u32 s7, s7, s58
    s_lshl_b32 s7, s7, 13
    v_lshlrev_b32 v107, 4, v12
    v_lshl_add_u32 v107, v9, 10, v107
    buffer_load_dwordx4 v[108:111], v107, s[24:27], s7 offen offset:384
    s_mul_i32 s7, s4, 7
    s_lshr_b32 s7, s7, 1
    s_or_b32 s49, s7, 3
    s_bfe_u32 s7, s49, 0x10002
    s_lshl_b32 s49, s49, 7
    s_lshl_b32 s62, s5, 4
    s_add_u32 s7, s7, s62
    s_mul_i32 s7, s7, 3584
    s_add_u32 s7, s7, s49
    v_mul_u32_u24 v107, 7168, v9
    v_lshl_add_u32 v107, v12, 4, v107
    s_cmp_eq_u32 s3, 0
    s_cbranch_scc1 L_a_pg
    buffer_load_dwordx4 v[112:115], v107, s[32:35], s7 offen
    s_branch L_a_px
L_a_pg:
    buffer_load_dwordx4 v[112:115], v107, s[28:31], s7 offen
L_a_px:
    s_barrier
    s_cmp_ge_u32 s5, 16
    s_cbranch_scc1 L_aw1
    s_branch L_aw2
L_aw1:
L_aw2:
    s_barrier
    s_barrier
    s_cmp_ge_u32 s5, 16
    s_cbranch_scc1 L_a_gd
    s_lshl_b32 s53, s4, 15
    s_and_b32 s7, s5, 1
    s_lshl_b32 s7, s7, 3
    s_lshl_b32 s7, s7, 11
    s_add_u32 s53, s53, s7
    s_bfe_u32 s7, s5, 0x30001
    s_xor_b32 s7, s7, 4
    s_lshl_b32 s7, s7, 8
    s_add_u32 s53, s53, s7
    s_lshl_b32 s7, s3, 7
    s_add_u32 s53, s53, s7
    s_add_u32 s53, s53, 1310720
    v_lshlrev_b32 v6, 4, v12
    v_lshl_add_u32 v6, v9, 11, v6
    v_and_b32 v4, 3, v1
    v_mul_u32_u24 v15, 320, v4
    v_lshl_add_u32 v15, v9, 4, v15
    v_bfe_u32 v4, v1, 2, 1
    v_mul_i32_i24 v4, -16352, v4
    s_lshl_b32 s7, s3, 7
    s_add_u32 s7, s7, 132352
    v_add3_u32 v15, v15, v4, s7
    s_barrier
    s_lshl_b32 s7, s5, 2
    s_add_u32 s7, s7, s6
    s_add_u32 s7, s7, 43008
    s_cmp_eq_u32 s3, 0
    s_cselect_b64 exec, 1, 0
    buffer_store_dword v1, off, s[40:43], s7 offset:0
    s_mov_b64 exec, -1
    ds_read_b128 v[24:27], v15 offset:0
    ds_read_b128 v[28:31], v15 offset:1280
    ds_read_b128 v[32:35], v15 offset:2560
    ds_read_b128 v[36:39], v15 offset:3840
    ds_read_b128 v[40:43], v15 offset:5120
    ds_read_b128 v[44:47], v15 offset:6400
    ds_read_b128 v[48:51], v15 offset:7680
    ds_read_b128 v[52:55], v15 offset:8960
    s_waitcnt lgkmcnt(6)
    v_pk_add_f32 v[24:25], v[24:25], v[28:29]
    v_pk_add_f32 v[26:27], v[26:27], v[30:31]
    s_waitcnt lgkmcnt(4)
    v_pk_add_f32 v[32:33], v[32:33], v[36:37]
    v_pk_add_f32 v[34:35], v[34:35], v[38:39]
    v_pk_add_f32 v[24:25], v[24:25], v[32:33]
    v_pk_add_f32 v[26:27], v[26:27], v[34:35]
    s_waitcnt lgkmcnt(2)
    v_pk_add_f32 v[40:41], v[40:41], v[44:45]
    v_pk_add_f32 v[42:43], v[42:43], v[46:47]
    s_waitcnt lgkmcnt(0)
    v_pk_add_f32 v[48:49], v[48:49], v[52:53]
    v_pk_add_f32 v[50:51], v[50:51], v[54:55]
    v_pk_add_f32 v[40:41], v[40:41], v[48:49]
    v_pk_add_f32 v[42:43], v[42:43], v[50:51]
    v_pk_add_f32 v[24:25], v[24:25], v[40:41]
    v_pk_add_f32 v[26:27], v[26:27], v[42:43]
    v_bfi_b32 v24, v104, s48, v24
    v_bfi_b32 v25, v104, s48, v25
    v_bfi_b32 v26, v104, s48, v26
    v_bfi_b32 v27, v104, s48, v27
    buffer_store_dwordx4 v[24:27], v6, s[40:43], s53 offen sc1
    s_cmp_lg_u32 s3, 0
    s_cbranch_scc1 L_a_end
    s_and_b32 s50, s5, 1
    s_lshr_b32 s61, s5, 1
    s_lshl_b32 s7, s4, 3
    s_add_u32 s7, s7, s61
    s_lshl_b32 s52, s7, 7
    s_lshl_b32 s62, s7, 4
    s_lshl_b32 s7, s50, 13
    s_add_u32 s52, s52, s7
    s_add_u32 s52, s52, 3145728
    s_lshl_b32 s7, s50, 12
    s_add_u32 s62, s62, s7
    v_lshlrev_b32 v5, 4, v12
    v_lshl_add_u32 v5, v9, 14, v5
    v_and_b32 v2, 3, v1
    v_bfe_u32 v3, v1, 2, 1
    v_lshrrev_b32 v4, 5, v1
    v_lshlrev_b32 v4, 2, v4
    v_lshl_add_u32 v4, v3, 3, v4
    v_lshl_add_u32 v6, v2, 10, v4
    v_lshl_add_u32 v4, v2, 7, v4
    s_lshl_b32 s61, s61, 4
    s_lshl_b32 s7, s50, 9
    s_add_u32 s61, s61, s7
    s_add_u32 s61, s61, s6
    s_add_u32 s61, s61, 40960
    s_xor_b32 s53, s61, 65536
    s_cmp_eq_u32 s97, 0
    s_cselect_b32 s51, s61, s53
    s_and_b32 s49, s48, 0xff
    s_cmp_ge_u32 s5, 8
    s_cbranch_scc1 L_h_poll
    s_barrier
L_h_poll:
    s_sub_u32 s96, s96, 1
    s_cbranch_scc1 L_end
    buffer_load_dword v22, v4, s[40:43], s51 offen sc1
    s_waitcnt vmcnt(0)
    v_cmp_eq_u32 vcc, -1, v22
    s_cbranch_vccnz L_h_poll
    v_lshlrev_b32 v20, 16, v22
    v_and_b32 v21, s56, v22
    s_cmp_lg_u32 s97, 0
    s_cbranch_scc1 L_fg_x
    s_add_u32 s51, s6, 43200
    v_min_u32 v122, 13, v1
    v_lshlrev_b32 v122, 2, v122
L_fg:
    s_sub_u32 s96, s96, 1
    s_cbranch_scc1 L_end
    buffer_load_dword v123, v122, s[40:43], s51 offen sc1
    s_waitcnt vmcnt(0)
    v_cmp_eq_u32 vcc, -1, v123
    s_cbranch_vccnz L_fg
L_fg_x:
    s_mov_b32 s51, s52
    buffer_load_dwordx4 v[24:27], v5, s[40:43], s51 offen sc1
    s_add_u32 s51, s51, 131072
    buffer_load_dwordx4 v[28:31], v5, s[40:43], s51 offen sc1
    s_add_u32 s51, s51, 131072
    buffer_load_dwordx4 v[32:35], v5, s[40:43], s51 offen sc1
    s_add_u32 s51, s51, 131072
    buffer_load_dwordx4 v[36:39], v5, s[40:43], s51 offen sc1
    s_add_u32 s51, s51, 131072
    buffer_load_dwordx4 v[40:43], v5, s[40:43], s51 offen sc1
    s_add_u32 s51, s51, 131072
    buffer_load_dwordx4 v[44:47], v5, s[40:43], s51 offen sc1
    s_add_u32 s51, s51, 131072
    buffer_load_dwordx4 v[48:51], v5, s[40:43], s51 offen sc1
    s_branch L_f_poll_c
L_f_poll:
    s_wqm_b64 exec, vcc
    s_sub_u32 s96, s96, 1
    s_cbranch_scc1 L_end
    s_mov_b32 s51, s52
    buffer_load_dwordx4 v[24:27], v5, s[40:43], s51 offen sc1
    s_add_u32 s51, s51, 131072
    buffer_load_dwordx4 v[28:31], v5, s[40:43], s51 offen sc1
    s_add_u32 s51, s51, 131072
    buffer_load_dwordx4 v[32:35], v5, s[40:43], s51 offen sc1
    s_add_u32 s51, s51, 131072
    buffer_load_dwordx4 v[36:39], v5, s[40:43], s51 offen sc1
    s_add_u32 s51, s51, 131072
    buffer_load_dwordx4 v[40:43], v5, s[40:43], s51 offen sc1
    s_add_u32 s51, s51, 131072
    buffer_load_dwordx4 v[44:47], v5, s[40:43], s51 offen sc1
    s_add_u32 s51, s51, 131072
    buffer_load_dwordx4 v[48:51], v5, s[40:43], s51 offen sc1
    s_mov_b64 exec, -1
L_f_poll_c:
    s_waitcnt vmcnt(6)
    v_xor_b32 v56, s49, v24
    v_xor_b32 v57, s49, v25
    v_xor_b32 v58, s49, v26
    v_xor_b32 v59, s49, v27
    v_or3_b32 v102, v56, v57, v58
    v_or_b32 v102, v102, v59
    s_waitcnt vmcnt(5)
    v_xor_b32 v60, s49, v28
    v_xor_b32 v61, s49, v29
    v_xor_b32 v62, s49, v30
    v_xor_b32 v63, s49, v31
    v_or3_b32 v102, v102, v60, v61
    v_or3_b32 v102, v102, v62, v63
    v_pk_add_f32 v[96:97], v[56:57], v[60:61]
    v_pk_add_f32 v[98:99], v[58:59], v[62:63]
    s_waitcnt vmcnt(4)
    v_xor_b32 v64, s49, v32
    v_xor_b32 v65, s49, v33
    v_xor_b32 v66, s49, v34
    v_xor_b32 v67, s49, v35
    v_or3_b32 v102, v102, v64, v65
    v_or3_b32 v102, v102, v66, v67
    v_pk_add_f32 v[96:97], v[96:97], v[64:65]
    v_pk_add_f32 v[98:99], v[98:99], v[66:67]
    s_waitcnt vmcnt(3)
    v_xor_b32 v68, s49, v36
    v_xor_b32 v69, s49, v37
    v_xor_b32 v70, s49, v38
    v_xor_b32 v71, s49, v39
    v_or3_b32 v102, v102, v68, v69
    v_or3_b32 v102, v102, v70, v71
    v_pk_add_f32 v[96:97], v[96:97], v[68:69]
    v_pk_add_f32 v[98:99], v[98:99], v[70:71]
    s_waitcnt vmcnt(2)
    v_xor_b32 v72, s49, v40
    v_xor_b32 v73, s49, v41
    v_xor_b32 v74, s49, v42
    v_xor_b32 v75, s49, v43
    v_or3_b32 v102, v102, v72, v73
    v_or3_b32 v102, v102, v74, v75
    v_pk_add_f32 v[96:97], v[96:97], v[72:73]
    v_pk_add_f32 v[98:99], v[98:99], v[74:75]
    s_waitcnt vmcnt(1)
    v_xor_b32 v76, s49, v44
    v_xor_b32 v77, s49, v45
    v_xor_b32 v78, s49, v46
    v_xor_b32 v79, s49, v47
    v_or3_b32 v102, v102, v76, v77
    v_or3_b32 v102, v102, v78, v79
    v_pk_add_f32 v[96:97], v[96:97], v[76:77]
    v_pk_add_f32 v[98:99], v[98:99], v[78:79]
    s_waitcnt vmcnt(0)
    v_xor_b32 v80, s49, v48
    v_xor_b32 v81, s49, v49
    v_xor_b32 v82, s49, v50
    v_xor_b32 v83, s49, v51
    v_or3_b32 v102, v102, v80, v81
    v_or3_b32 v102, v102, v82, v83
    v_pk_add_f32 v[96:97], v[96:97], v[80:81]
    v_pk_add_f32 v[98:99], v[98:99], v[82:83]
    s_nop 1
    v_permlane32_swap_b32 v96, v98
    v_permlane32_swap_b32 v97, v99
    v_and_b32 v102, 0xff, v102
    v_cmp_ne_u32 vcc, 0, v102
    v_pk_add_f32 v[96:97], v[96:97], v[98:99]
    s_cbranch_vccnz L_f_poll
    v_mov_b32 v98, v96
    v_mov_b32 v99, v97
    s_nop 0
    v_permlane16_swap_b32 v96, v98
    v_permlane16_swap_b32 v97, v99
    v_pk_add_f32 v[96:97], v[96:97], v[98:99]
    s_nop 1
    v_add_f32_dpp v96, v96, v96 row_ror:8 row_mask:0xf bank_mask:0xf
    v_add_f32_dpp v97, v97, v97 row_ror:8 row_mask:0xf bank_mask:0xf
    v_cvt_pk_bf16_f32 v98, v96, v97
    v_lshlrev_b32 v22, 16, v98
    v_and_b32 v23, s56, v98
    v_pk_add_f32 v[22:23], v[22:23], v[20:21]
    v_cvt_pk_bf16_f32 v22, v22, v23
    s_mov_b32 exec_lo, 0xff
    s_mov_b32 exec_hi, 0xff
    buffer_store_dword v22, v6, s[36:39], s62 offen
    s_cmp_lg_u32 s62, 0
    s_cbranch_scc1 L_a_end
    v_mov_b32 v22, s48
    s_mov_b64 exec, 1
    buffer_store_dword v22, off, s[40:43], 0
    s_branch L_a_end
L_a_gd:
    s_cmp_ge_u32 s5, 30
    s_cbranch_scc1 L_a_end
    v_lshrrev_b32 v4, 5, v1
    v_bfe_u32 v13, v1, 2, 1
    v_lshl_add_u32 v13, v4, 1, v13
    v_mul_u32_u24 v15, 320, v13
    v_and_b32 v13, 3, v9
    v_lshl_add_u32 v15, v13, 4, v15
    v_and_b32 v13, 3, v1
    v_lshl_add_u32 v15, v13, 2, v15
    s_lshl_b32 s7, s3, 7
    s_add_u32 s7, s7, 132352
    v_add_u32 v15, s7, v15
    v_lshlrev_b32 v14, 1, v12
    v_lshl_add_u32 v14, v4, 4, v14
    v_and_b32 v13, 3, v9
    v_lshl_add_u32 v14, v13, 6, v14
    s_lshl_b32 s7, s3, 5
    s_add_u32 s7, s7, 142592
    v_add_u32 v14, s7, v14
    v_add_u32 v4, 64, v15
    s_mov_b32 s57, 0xbfb8aa3b
    s_barrier
    ds_read2st64_b32 v[24:25], v15 offset0:0 offset1:5
    ds_read2st64_b32 v[26:27], v15 offset0:10 offset1:15
    ds_read2st64_b32 v[28:29], v15 offset0:20 offset1:25
    ds_read2st64_b32 v[30:31], v15 offset0:30 offset1:35
    ds_read2st64_b32 v[32:33], v4 offset0:0 offset1:5
    ds_read2st64_b32 v[34:35], v4 offset0:10 offset1:15
    ds_read2st64_b32 v[36:37], v4 offset0:20 offset1:25
    ds_read2st64_b32 v[38:39], v4 offset0:30 offset1:35
    s_waitcnt lgkmcnt(4)
    v_pk_add_f32 v[24:25], v[24:25], v[26:27]
    v_pk_add_f32 v[28:29], v[28:29], v[30:31]
    v_pk_add_f32 v[24:25], v[24:25], v[28:29]
    v_add_f32 v24, v24, v25
    v_cvt_pk_bf16_f32 v24, v24, v24
    v_and_b32 v26, s56, v24
    v_mul_f32 v26, s57, v26
    v_exp_f32 v26, v26
    s_waitcnt lgkmcnt(0)
    v_pk_add_f32 v[32:33], v[32:33], v[34:35]
    v_pk_add_f32 v[36:37], v[36:37], v[38:39]
    v_add_f32 v26, 1.0, v26
    v_rcp_f32 v26, v26
    v_pk_add_f32 v[32:33], v[32:33], v[36:37]
    v_add_f32 v25, v32, v33
    v_cvt_pk_bf16_f32 v26, v26, v25
    v_lshlrev_b32 v25, 16, v26
    v_and_b32 v26, s56, v26
    v_mul_f32 v26, v26, v25
    v_cvt_pk_bf16_f32 v26, v26, v26
    ds_write_b16 v14, v26
    s_waitcnt lgkmcnt(0)
    s_barrier
    s_lshl_b32 s7, s5, 2
    s_add_u32 s7, s7, s6
    s_add_u32 s7, s7, 43008
    s_cmp_eq_u32 s3, 0
    s_cselect_b64 exec, 1, 0
    buffer_store_dword v1, off, s[40:43], s7 offset:128
    s_mov_b64 exec, -1
L_a_end:
L_end:
    s_endpgm

.section .rodata,"a"
.p2align 6
.amdhsa_kernel sequential_preLN__sliding_block_cached__glu_gated_glu__decode_kernel
  .amdhsa_next_free_vgpr 128
  .amdhsa_next_free_sgpr 102
  .amdhsa_accum_offset 128
  .amdhsa_group_segment_fixed_size 0
  .amdhsa_kernarg_size 96
  .amdhsa_user_sgpr_count 2
  .amdhsa_user_sgpr_kernarg_segment_ptr 1
  .amdhsa_system_sgpr_workgroup_id_x 1
.end_amdhsa_kernel
```
